```python
import torch

def _softmax(x, axis=-1):
    return torch.softmax(x, dim=axis)
def _gelu(x):
    return torch.nn.functional.gelu(x, approximate="tanh")
def _silu(x):
    return torch.nn.functional.silu(x)
def _sigmoid(x):
    return torch.sigmoid(x)
def _layernorm(x, axis=-1, eps=1e-5):
    m = x.mean(dim=axis, keepdim=True)
    v = x.var(dim=axis, keepdim=True, unbiased=False)
    return (x - m) / torch.sqrt(v + eps)
def _scatter_add(tgt, idx, src, axis=0):
    return tgt.clone().index_add_(axis, idx, src)
def _segment_sum(src, seg, n):
    out = torch.zeros((n,) + src.shape[1:], dtype=src.dtype)
    return out.index_add_(0, seg, src)
def _pad(x, pw):
    flat = tuple(v for pair in reversed(pw) for v in pair)
    return torch.nn.functional.pad(x, flat)

kernel_name = 'parallel_sum__compressed_kv_cla__glu_gated_swiglu__decode'

def setup_inputs():

    _w = (lambda a: (lambda t: t.to(torch.bfloat16) if t.is_floating_point() else t)(torch.as_tensor(a)))
    def _A_setup():
        B, H, Sq, Sk, D, M = 2, 32, 1, 8192, 128, 512
        Dc = 4 * D
        return {
            "x": _w((lambda *s: torch.randn(*s, dtype=torch.bfloat16) * 0.05)(B, Sq, M)),
            "c_kv": _w((lambda *s: torch.randn(*s, dtype=torch.bfloat16) * 0.8)(B, Sk, Dc)),
            "w_q": _w((lambda *s: torch.randn(*s, dtype=torch.bfloat16) * 1.6)(M, H, D) * (M ** -0.5)),
            "w_uk": _w((lambda *s: torch.randn(*s, dtype=torch.bfloat16) * 1.6)(Dc, H, D) * (Dc ** -0.5)),
            "w_uv": _w((lambda *s: torch.randn(*s, dtype=torch.bfloat16) * 0.8)(Dc, H, D) * (Dc ** -0.5)),
            "w_o": _w((lambda *s: torch.randn(*s, dtype=torch.bfloat16) * 0.8)(H, D, M) * ((H * D) ** -0.5)),
        }
    _A_in = _A_setup()

    def _B_setup():
        B, S, D, F = 2, 1, 512, 1376
        return {
            "x": _w((lambda *s: torch.randn(*s, dtype=torch.bfloat16) * 0.05)(B, S, D)),
            "w1": _w((lambda *s: torch.randn(*s, dtype=torch.bfloat16) * 0.2)(D, F) * (2.0 / D) ** 0.5),
            "w3": _w((lambda *s: torch.randn(*s, dtype=torch.bfloat16) * 0.2)(D, F) * (2.0 / D) ** 0.5),
            "w2": _w((lambda *s: torch.randn(*s, dtype=torch.bfloat16) * 0.2)(F, D) * (2.0 / F) ** 0.5),
        }
    _B_in = _B_setup()

    return {
        "A_x": _A_in["x"],
        "A_c_kv": _A_in["c_kv"],
        "A_w_q": _A_in["w_q"],
        "A_w_uk": _A_in["w_uk"],
        "A_w_uv": _A_in["w_uv"],
        "A_w_o": _A_in["w_o"],
        "B_x": _B_in["x"],
        "B_w1": _B_in["w1"],
        "B_w3": _B_in["w3"],
        "B_w2": _B_in["w2"],
    }

def reference(A_x, A_c_kv, A_w_q, A_w_uk, A_w_uv, A_w_o, B_x, B_w1, B_w3, B_w2):
    def _A_ref(x, c_kv, w_q, w_uk, w_uv, w_o):
        B, Sq, M = x.shape[0], x.shape[1], x.shape[2]
        Sk = c_kv.shape[1]
        H, D = w_q.shape[1], w_q.shape[2]
        q = torch.einsum("bqm,mhd->bhqd", x, w_q)
        k = torch.einsum("bkc,chd->bhkd", c_kv, w_uk)
        v = torch.einsum("bkc,chd->bhkd", c_kv, w_uv)
        scores = torch.einsum("bhqd,bhkd->bhqk", q, k) * (D ** -0.5)
        off = Sk - Sq
        qi = torch.arange(Sq)[:, None]
        kj = torch.arange(Sk)[None, :]
        cmask = kj <= (qi + off)
        scores = torch.where(cmask[None, None], scores, -1e9)
        p = _softmax(scores, axis=-1)
        ctx = torch.einsum("bhqk,bhkd->bhqd", p, v)
        return torch.einsum("bhqd,hdm->bqm", ctx, w_o)

    def _B_ref(x, w1, w3, w2):
        gate = torch.einsum("bsd,df->bsf", x, w1)
        up = torch.einsum("bsd,df->bsf", x, w3)
        h = _silu(gate) * up
        out = torch.einsum("bsf,fd->bsd", h, w2)
        return out

    x = A_x
    xn = _layernorm(x, axis=-1)
    return x + _A_ref(xn, A_c_kv, A_w_q, A_w_uk, A_w_uv, A_w_o) + _B_ref(xn, B_w1, B_w3, B_w2)
```

```asm
; @launch grid=(256,1,1) block=(256,1,1) lds=163840
.amdgcn_target "amdgcn-amd-amdhsa--gfx950"
.text
.globl parallel_sum__compressed_kv_cla__glu_gated_swiglu__decode_kernel
.p2align 8
.type parallel_sum__compressed_kv_cla__glu_gated_swiglu__decode_kernel,@function
parallel_sum__compressed_kv_cla__glu_gated_swiglu__decode_kernel:
  s_cmp_ge_u32 s2, 256
  s_cbranch_scc1 L_end
  s_load_dwordx16 s[64:79], s[0:1], 0
  s_load_dwordx8 s[80:87], s[0:1], 64
  s_load_dwordx2 s[88:89], s[0:1], 96
  v_and_b32 v1, 63, v0
  v_lshrrev_b32 v8, 6, v0
  v_and_b32 v2, 15, v0
  v_readfirstlane_b32 s3, v8
  v_lshrrev_b32 v3, 4, v1
  v_lshlrev_b32 v4, 4, v1
  s_mov_b32 s44, 0xffff0000
  s_mov_b32 s45, 0xffff0000
  s_mov_b32 s46, 0
  s_mov_b32 s47, -1
  s_mov_b32 s63, s2
  s_cmp_ge_u32 s2, 128
  s_cbranch_scc1 L_att
  v_lshlrev_b32 v8, 1, v3
  v_xor_b32 v8, v8, v2
  v_lshlrev_b32 v5, 4, v8
  s_and_b32 s28, s2, 7
  s_lshl_b32 s28, s28, 2
  s_bfe_u32 s29, s2, 0x20003
  s_add_u32 s4, s28, s29
  s_lshr_b32 s5, s2, 5
  s_and_b32 s28, s2, 7
  s_sub_u32 s28, s28, 4
  s_lshl_b32 s62, s28, 4
  s_lshr_b32 s29, s2, 3
  s_add_u32 s62, s62, s29
  s_cmp_lt_u32 s28, 2
  s_cselect_b32 s62, s62, 255
  v_lshl_add_u32 v58, v3, 13, v5
  v_xor_b32 v59, 128, v58
  s_lshl_b32 s29, s5, 7
  s_lshl_b32 s28, s3, 5
  s_add_u32 s29, s29, s28
  s_lshl_b32 s29, s29, 13
  s_lshl_b32 s28, s4, 8
  s_add_u32 s29, s29, s28
  s_waitcnt lgkmcnt(0)
  s_mov_b32 s12, s64
  s_and_b32 s13, s65, 0xffff
  s_mov_b32 s14, 2048
  s_mov_b32 s15, 0x20000
  s_mov_b32 s16, s68
  s_and_b32 s17, s69, 0xffff
  s_mov_b32 s18, 4194304
  s_mov_b32 s19, 0x20000
  s_lshr_b32 s37, s3, 1
  s_lshl_b32 s37, s37, 10
  buffer_load_dwordx4 v[8:11], v4, s[12:15], s37 offen
  s_lshl_b32 s31, s3, 13
  s_mov_b32 s30, s29
  s_add_u32 m0, s31, 8192
  s_nop 0
  buffer_load_dwordx4 v58, s[16:19], s30 offen nt lds
  s_add_u32 s30, s29, 32768
  s_add_u32 m0, s31, 9216
  s_nop 0
  buffer_load_dwordx4 v58, s[16:19], s30 offen nt lds
  s_add_u32 s30, s29, 65536
  s_add_u32 m0, s31, 10240
  s_nop 0
  buffer_load_dwordx4 v59, s[16:19], s30 offen nt lds
  s_add_u32 s30, s29, 98304
  s_add_u32 m0, s31, 11264
  s_nop 0
  buffer_load_dwordx4 v59, s[16:19], s30 offen nt lds
  s_add_u32 s30, s29, 131072
  s_add_u32 m0, s31, 12288
  s_nop 0
  buffer_load_dwordx4 v58, s[16:19], s30 offen nt lds
  s_add_u32 s30, s29, 163840
  s_add_u32 m0, s31, 13312
  s_nop 0
  buffer_load_dwordx4 v58, s[16:19], s30 offen nt lds
  s_add_u32 s30, s29, 196608
  s_add_u32 m0, s31, 14336
  s_nop 0
  buffer_load_dwordx4 v59, s[16:19], s30 offen nt lds
  s_add_u32 s30, s29, 229376
  s_add_u32 m0, s31, 15360
  s_nop 0
  buffer_load_dwordx4 v59, s[16:19], s30 offen nt lds
  s_load_dword s6, s[88:89], 0
  s_mov_b32 s20, s70
  s_and_b32 s21, s71, 0xffff
  s_mov_b32 s22, 4194304
  s_mov_b32 s23, 0x20000
  s_mov_b32 s36, s29
  s_mov_b32 s29, s36
  s_lshl_b32 s31, s3, 13
  s_mov_b32 s30, s29
  s_add_u32 m0, s31, 40960
  s_nop 0
  buffer_load_dwordx4 v58, s[20:23], s30 offen nt lds
  s_add_u32 s30, s29, 32768
  s_add_u32 m0, s31, 41984
  s_nop 0
  buffer_load_dwordx4 v58, s[20:23], s30 offen nt lds
  s_add_u32 s30, s29, 65536
  s_add_u32 m0, s31, 43008
  s_nop 0
  buffer_load_dwordx4 v59, s[20:23], s30 offen nt lds
  s_add_u32 s30, s29, 98304
  s_add_u32 m0, s31, 44032
  s_nop 0
  buffer_load_dwordx4 v59, s[20:23], s30 offen nt lds
  s_add_u32 s30, s29, 131072
  s_add_u32 m0, s31, 45056
  s_nop 0
  buffer_load_dwordx4 v58, s[20:23], s30 offen nt lds
  s_add_u32 s30, s29, 163840
  s_add_u32 m0, s31, 46080
  s_nop 0
  buffer_load_dwordx4 v58, s[20:23], s30 offen nt lds
  s_add_u32 s30, s29, 196608
  s_add_u32 m0, s31, 47104
  s_nop 0
  buffer_load_dwordx4 v59, s[20:23], s30 offen nt lds
  s_add_u32 s30, s29, 229376
  s_add_u32 m0, s31, 48128
  s_nop 0
  buffer_load_dwordx4 v59, s[20:23], s30 offen nt lds
  s_mov_b32 s8, s88
  s_and_b32 s9, s89, 0xffff
  s_mov_b32 s10, 268435456
  s_mov_b32 s11, 0x20000
  s_lshl_b32 s32, s4, 2
  s_add_u32 s32, s32, s3
  s_lshl_b32 s32, s32, 11
  s_add_u32 s28, s32, 1638400
  buffer_load_dwordx4 v[232:235], v4, s[8:11], s28 offen sc1
  buffer_load_dwordx4 v[236:239], v4, s[8:11], s28 offen offset:1024 sc1
  v_bfe_u32 v17, v1, 2, 2
  v_and_b32 v18, 3, v1
  v_and_b32 v19, 1, v3
  v_lshl_add_u32 v20, v19, 2, v17
  v_lshlrev_b32 v20, 1, v20
  s_lshl_b32 s28, s3, 2
  v_xor_b32 v20, s28, v20
  v_lshrrev_b32 v21, 1, v18
  v_add_u32 v20, v20, v21
  v_lshlrev_b32 v20, 4, v20
  v_and_b32 v21, 1, v18
  v_lshl_add_u32 v20, v21, 3, v20
  v_lshl_add_u32 v21, v3, 3, v17
  v_lshl_add_u32 v6, v21, 8, v20
  v_xor_b32 v7, 32, v6
  v_lshrrev_b32 v20, 1, v3
  v_lshlrev_b32 v20, 8, v20
  v_lshl_add_u32 v21, v19, 4, v2
  s_lshl_b32 s28, s3, 5
  v_add_u32 v21, s28, v21
  v_lshl_add_u32 v56, v21, 1, v20
  v_and_b32 v20, 1, v1
  v_lshlrev_b32 v20, 8, v20
  v_lshl_add_u32 v57, v3, 4, v20
  v_lshlrev_b32 v55, 4, v2
  v_lshl_add_u32 v55, v3, 10, v55
  s_lshl_b32 s32, s4, 2
  s_add_u32 s32, s32, s3
  s_lshl_b32 s32, s32, 11
  s_lshl_b32 s33, s5, 8
  s_add_u32 s33, s33, s32
  v_and_b32 v52, 1, v1
  v_lshlrev_b32 v52, 10, v52
  v_lshl_add_u32 v52, v3, 4, v52
  s_lshl_b32 s28, s5, 8
  s_add_u32 s28, s28, 0
  v_add_u32 v52, s28, v52
  v_and_b32 v22, 3, v1
  v_bfe_u32 v23, v1, 3, 1
  v_lshl_add_u32 v22, v23, 2, v22
  v_lshlrev_b32 v22, 1, v22
  v_xor_b32 v22, v22, v3
  v_lshlrev_b32 v23, 8, v2
  s_lshl_b32 s28, s3, 13
  s_add_u32 s28, s28, 40960
  v_add_u32 v23, s28, v23
  v_xor_b32 v24, 0, v22
  v_lshl_add_u32 v248, v24, 4, v23
  v_xor_b32 v24, 4, v22
  v_lshl_add_u32 v249, v24, 4, v23
  v_xor_b32 v24, 8, v22
  v_lshl_add_u32 v250, v24, 4, v23
  v_xor_b32 v24, 12, v22
  v_lshl_add_u32 v251, v24, 4, v23
  s_waitcnt vmcnt(18)
  v_lshlrev_b32 v16, 16, v8
  v_and_b32 v17, 0xffff0000, v8
  v_lshlrev_b32 v18, 16, v9
  v_and_b32 v19, 0xffff0000, v9
  v_lshlrev_b32 v20, 16, v10
  v_and_b32 v21, 0xffff0000, v10
  v_lshlrev_b32 v22, 16, v11
  v_and_b32 v23, 0xffff0000, v11
  v_readfirstlane_b32 s28, v16
  s_nop 1
  v_subrev_f32 v16, s28, v16
  v_subrev_f32 v17, s28, v17
  v_subrev_f32 v18, s28, v18
  v_subrev_f32 v19, s28, v19
  v_subrev_f32 v20, s28, v20
  v_subrev_f32 v21, s28, v21
  v_subrev_f32 v22, s28, v22
  v_subrev_f32 v23, s28, v23
  v_add_f32 v24, v16, v17
  v_mul_f32 v25, v16, v16
  v_fmac_f32 v25, v17, v17
  v_add_f32 v24, v24, v18
  v_fmac_f32 v25, v18, v18
  v_add_f32 v24, v24, v19
  v_fmac_f32 v25, v19, v19
  v_add_f32 v24, v24, v20
  v_fmac_f32 v25, v20, v20
  v_add_f32 v24, v24, v21
  v_fmac_f32 v25, v21, v21
  v_add_f32 v24, v24, v22
  v_fmac_f32 v25, v22, v22
  v_add_f32 v24, v24, v23
  v_fmac_f32 v25, v23, v23
  s_nop 0
  v_add_f32_dpp v24, v24, v24 row_ror:8 row_mask:0xf bank_mask:0xf
  v_add_f32_dpp v25, v25, v25 row_ror:8 row_mask:0xf bank_mask:0xf
  s_nop 0
  v_add_f32_dpp v24, v24, v24 row_ror:4 row_mask:0xf bank_mask:0xf
  v_add_f32_dpp v25, v25, v25 row_ror:4 row_mask:0xf bank_mask:0xf
  s_nop 0
  v_add_f32_dpp v24, v24, v24 row_ror:2 row_mask:0xf bank_mask:0xf
  v_add_f32_dpp v25, v25, v25 row_ror:2 row_mask:0xf bank_mask:0xf
  s_nop 0
  v_add_f32_dpp v24, v24, v24 row_ror:1 row_mask:0xf bank_mask:0xf
  v_add_f32_dpp v25, v25, v25 row_ror:1 row_mask:0xf bank_mask:0xf
  v_mov_b32 v26, v24
  v_mov_b32 v27, v25
  s_nop 0
  v_permlane16_swap_b32 v24, v26
  v_permlane16_swap_b32 v25, v27
  s_nop 0
  v_add_f32 v24, v24, v26
  v_add_f32 v25, v25, v27
  v_mov_b32 v26, v24
  v_mov_b32 v27, v25
  s_nop 0
  v_permlane32_swap_b32 v24, v26
  v_permlane32_swap_b32 v25, v27
  s_nop 0
  v_add_f32 v24, v24, v26
  v_add_f32 v25, v25, v27
  s_mov_b32 s29, 0x3b000000
  v_mul_f32 v24, s29, v24
  v_mul_f32 v25, s29, v25
  v_fma_f32 v25, -v24, v24, v25
  v_add_f32 v28, s28, v24
  v_max_f32 v25, 0, v25
  v_cvt_pk_bf16_f32 v28, v28, v28
  v_cvt_pk_bf16_f32 v25, v25, v25
  v_lshlrev_b32 v28, 16, v28
  v_lshlrev_b32 v25, 16, v25
  s_mov_b32 s29, 0x3727c5ac
  v_add_f32 v25, s29, v25
  v_subrev_f32 v28, s28, v28
  v_cvt_pk_bf16_f32 v25, v25, v25
  v_lshlrev_b32 v25, 16, v25
  v_sqrt_f32 v25, v25
  v_sub_f32 v16, v16, v28
  v_sub_f32 v17, v17, v28
  v_sub_f32 v18, v18, v28
  v_sub_f32 v19, v19, v28
  v_cvt_pk_bf16_f32 v25, v25, v25
  v_sub_f32 v20, v20, v28
  v_sub_f32 v21, v21, v28
  v_sub_f32 v22, v22, v28
  v_sub_f32 v23, v23, v28
  v_lshlrev_b32 v25, 16, v25
  v_rcp_f32 v25, v25
  v_cvt_pk_bf16_f32 v40, v16, v17
  v_cvt_pk_bf16_f32 v41, v18, v19
  v_cvt_pk_bf16_f32 v42, v20, v21
  v_cvt_pk_bf16_f32 v43, v22, v23
  v_lshlrev_b32 v16, 16, v40
  v_and_b32 v17, 0xffff0000, v40
  v_lshlrev_b32 v18, 16, v41
  v_and_b32 v19, 0xffff0000, v41
  v_lshlrev_b32 v20, 16, v42
  v_and_b32 v21, 0xffff0000, v42
  v_lshlrev_b32 v22, 16, v43
  v_and_b32 v23, 0xffff0000, v43
  v_mul_f32 v16, v16, v25
  v_mul_f32 v17, v17, v25
  v_mul_f32 v18, v18, v25
  v_mul_f32 v19, v19, v25
  v_mul_f32 v20, v20, v25
  v_mul_f32 v21, v21, v25
  v_mul_f32 v22, v22, v25
  v_mul_f32 v23, v23, v25
  v_cvt_pk_bf16_f32 v40, v16, v17
  v_cvt_pk_bf16_f32 v41, v18, v19
  v_cvt_pk_bf16_f32 v42, v20, v21
  v_cvt_pk_bf16_f32 v43, v22, v23
  v_add_u32 v30, s37, v4
  ds_write_b128 v30, v[40:43] offset:0
  s_waitcnt vmcnt(10) lgkmcnt(0)
  s_barrier
  ds_read_b128 v[96:99], v52 offset:0
  ds_read_b128 v[100:103], v52 offset:64
  ds_read_b128 v[104:107], v52 offset:128
  ds_read_b128 v[108:111], v52 offset:192
  ds_read_b64_tr_b16 v[112:113], v6 offset:8192
  ds_read_b64_tr_b16 v[114:115], v6 offset:9216
  ds_read_b64_tr_b16 v[128:129], v7 offset:8192
  ds_read_b64_tr_b16 v[130:131], v7 offset:9216
  ds_read_b64_tr_b16 v[116:117], v6 offset:16384
  ds_read_b64_tr_b16 v[118:119], v6 offset:17408
  ds_read_b64_tr_b16 v[132:133], v7 offset:16384
  ds_read_b64_tr_b16 v[134:135], v7 offset:17408
  ds_read_b64_tr_b16 v[120:121], v6 offset:24576
  ds_read_b64_tr_b16 v[122:123], v6 offset:25600
  ds_read_b64_tr_b16 v[136:137], v7 offset:24576
  ds_read_b64_tr_b16 v[138:139], v7 offset:25600
  ds_read_b64_tr_b16 v[124:125], v6 offset:32768
  ds_read_b64_tr_b16 v[126:127], v6 offset:33792
  ds_read_b64_tr_b16 v[140:141], v7 offset:32768
  ds_read_b64_tr_b16 v[142:143], v7 offset:33792
  s_add_u32 s6, s6, 0x9e3779b9
  s_add_u32 s34, s33, 131072
  s_add_u32 s35, s33, 1638400
  v_mov_b32 v49, s6
  v_mov_b32 v51, s6
  s_waitcnt lgkmcnt(0)
  v_mfma_f32_16x16x32_bf16 v[144:147], v[96:99], v[112:115], 0
  v_mfma_f32_16x16x32_bf16 v[148:151], v[96:99], v[128:131], 0
  v_mfma_f32_16x16x32_bf16 v[144:147], v[100:103], v[116:119], v[144:147]
  v_mfma_f32_16x16x32_bf16 v[148:151], v[100:103], v[132:135], v[148:151]
  v_mfma_f32_16x16x32_bf16 v[144:147], v[104:107], v[120:123], v[144:147]
  v_mfma_f32_16x16x32_bf16 v[148:151], v[104:107], v[136:139], v[148:151]
  v_mfma_f32_16x16x32_bf16 v[144:147], v[108:111], v[124:127], v[144:147]
  v_mfma_f32_16x16x32_bf16 v[148:151], v[108:111], v[140:143], v[148:151]
  s_nop 8
  v_cndmask_b32 v48, v144, v148, s[44:45]
  v_cndmask_b32 v50, v145, v149, s[44:45]
  s_mov_b32 exec_lo, -1
  s_mov_b32 exec_hi, 0
  buffer_store_dwordx4 v[48:51], v55, s[8:11], s35 offen
  s_mov_b64 exec, -1
  s_mov_b32 s37, s34
  s_add_u32 s34, s32, 131072
  s_add_u32 s35, s32, 1638400
  s_waitcnt vmcnt(1)
  ds_read_b128 v[64:67], v248 offset:0
  ds_read_b128 v[68:71], v249 offset:0
  ds_read_b128 v[72:75], v250 offset:0
  ds_read_b128 v[76:79], v251 offset:0
  ds_read_b128 v[80:83], v248 offset:4096
  ds_read_b128 v[84:87], v249 offset:4096
  ds_read_b128 v[88:91], v250 offset:4096
  ds_read_b128 v[92:95], v251 offset:4096
  s_mov_b32 s49, 24
  buffer_load_dwordx4 v[224:227], v4, s[8:11], s35 offen sc1
  buffer_load_dwordx4 v[228:231], v4, s[8:11], s35 offen offset:1024 sc1
L_fp_1:
  buffer_load_dwordx4 v[232:235], v4, s[8:11], s35 offen sc1
  buffer_load_dwordx4 v[236:239], v4, s[8:11], s35 offen offset:1024 sc1
  s_waitcnt vmcnt(2)
  v_xor_b32 v61, s6, v225
  v_xor_b32 v62, s6, v227
  v_or_b32 v60, v61, v62
  v_xor_b32 v61, s6, v229
  v_xor_b32 v62, s6, v231
  v_or3_b32 v60, v60, v61, v62
  v_cmp_ne_u32 vcc, 0, v60
  s_cbranch_vccz L_fx0_2
  buffer_load_dwordx4 v[224:227], v4, s[8:11], s35 offen sc1
  buffer_load_dwordx4 v[228:231], v4, s[8:11], s35 offen offset:1024 sc1
  s_waitcnt vmcnt(2)
  v_xor_b32 v61, s6, v233
  v_xor_b32 v62, s6, v235
  v_or_b32 v60, v61, v62
  v_xor_b32 v61, s6, v237
  v_xor_b32 v62, s6, v239
  v_or3_b32 v60, v60, v61, v62
  v_cmp_ne_u32 vcc, 0, v60
  s_cbranch_vccz L_fx1_3
  s_sub_u32 s49, s49, 1
  s_cbranch_scc0 L_fp_1
  s_mov_b32 exec_lo, -1
  s_mov_b32 exec_hi, 0
  buffer_store_dwordx4 v[48:51], v55, s[8:11], s37 offen sc1
  s_mov_b64 exec, -1
  s_mov_b32 s48, 200000
  buffer_load_dwordx4 v[224:227], v4, s[8:11], s35 offen sc1
  buffer_load_dwordx4 v[228:231], v4, s[8:11], s35 offen offset:1024 sc1
  s_sleep 1
  buffer_load_dwordx4 v[232:235], v4, s[8:11], s34 offen sc1
  buffer_load_dwordx4 v[236:239], v4, s[8:11], s34 offen offset:1024 sc1
  s_sleep 1
L_poll_5:
  buffer_load_dwordx4 v[240:243], v4, s[8:11], s35 offen sc1
  buffer_load_dwordx4 v[244:247], v4, s[8:11], s35 offen offset:1024 sc1
  s_waitcnt vmcnt(4)
  v_xor_b32 v61, s6, v225
  v_xor_b32 v62, s6, v227
  v_or_b32 v60, v61, v62
  v_xor_b32 v61, s6, v229
  v_xor_b32 v62, s6, v231
  v_or3_b32 v60, v60, v61, v62
  v_cmp_ne_u32 vcc, 0, v60
  s_cbranch_vccz L_pexit_7
  s_sleep 1
  buffer_load_dwordx4 v[224:227], v4, s[8:11], s35 offen sc1
  buffer_load_dwordx4 v[228:231], v4, s[8:11], s35 offen offset:1024 sc1
  s_waitcnt vmcnt(4)
  v_xor_b32 v61, s6, v233
  v_xor_b32 v62, s6, v235
  v_or_b32 v60, v61, v62
  v_xor_b32 v61, s6, v237
  v_xor_b32 v62, s6, v239
  v_or3_b32 v60, v60, v61, v62
  v_cmp_ne_u32 vcc, 0, v60
  s_cbranch_vccz L_pexit_8
  s_sleep 1
  buffer_load_dwordx4 v[232:235], v4, s[8:11], s34 offen sc1
  buffer_load_dwordx4 v[236:239], v4, s[8:11], s34 offen offset:1024 sc1
  s_waitcnt vmcnt(4)
  v_xor_b32 v61, s6, v241
  v_xor_b32 v62, s6, v243
  v_or_b32 v60, v61, v62
  v_xor_b32 v61, s6, v245
  v_xor_b32 v62, s6, v247
  v_or3_b32 v60, v60, v61, v62
  v_cmp_ne_u32 vcc, 0, v60
  s_cbranch_vccz L_pexit_9
  s_sleep 1
  s_sub_u32 s48, s48, 1
  s_cbranch_scc0 L_poll_5
L_pexit_7:
  v_mov_b32 v40, v224
  v_mov_b32 v41, v225
  v_mov_b32 v42, v226
  v_mov_b32 v43, v227
  v_mov_b32 v44, v228
  v_mov_b32 v45, v229
  v_mov_b32 v46, v230
  v_mov_b32 v47, v231
  s_branch L_pdone_6
L_pexit_8:
  v_mov_b32 v40, v232
  v_mov_b32 v41, v233
  v_mov_b32 v42, v234
  v_mov_b32 v43, v235
  v_mov_b32 v44, v236
  v_mov_b32 v45, v237
  v_mov_b32 v46, v238
  v_mov_b32 v47, v239
  s_branch L_pdone_6
L_pexit_9:
  v_mov_b32 v40, v240
  v_mov_b32 v41, v241
  v_mov_b32 v42, v242
  v_mov_b32 v43, v243
  v_mov_b32 v44, v244
  v_mov_b32 v45, v245
  v_mov_b32 v46, v246
  v_mov_b32 v47, v247
L_pdone_6:
  s_branch L_fdone_4
L_fx0_2:
  v_mov_b32 v40, v224
  v_mov_b32 v41, v225
  v_mov_b32 v42, v226
  v_mov_b32 v43, v227
  v_mov_b32 v44, v228
  v_mov_b32 v45, v229
  v_mov_b32 v46, v230
  v_mov_b32 v47, v231
  s_mov_b32 exec_lo, -1
  s_mov_b32 exec_hi, 0
  buffer_store_dwordx4 v[48:51], v55, s[8:11], s37 offen sc1
  s_mov_b64 exec, -1
  s_branch L_fdone_4
L_fx1_3:
  v_mov_b32 v40, v232
  v_mov_b32 v41, v233
  v_mov_b32 v42, v234
  v_mov_b32 v43, v235
  v_mov_b32 v44, v236
  v_mov_b32 v45, v237
  v_mov_b32 v46, v238
  v_mov_b32 v47, v239
  s_mov_b32 exec_lo, -1
  s_mov_b32 exec_hi, 0
  buffer_store_dwordx4 v[48:51], v55, s[8:11], s37 offen sc1
  s_mov_b64 exec, -1
L_fdone_4:
  s_nop 0
  v_permlane32_swap_b32 v40, v42
  v_permlane32_swap_b32 v44, v46
  s_nop 0
  v_add_f32 v40, v40, v42
  v_add_f32 v44, v44, v46
  s_nop 1
  v_permlane16_swap_b32 v40, v44
  s_nop 0
  v_add_f32 v40, v40, v44
  v_cvt_pk_bf16_f32 v54, v40, v40
  ds_write_b16 v56, v54 offset:2048
  s_waitcnt lgkmcnt(0)
  s_barrier
  ds_read_b128 v[96:99], v57 offset:2048
  ds_read_b128 v[100:103], v57 offset:2112
  ds_read_b128 v[104:107], v57 offset:2176
  ds_read_b128 v[108:111], v57 offset:2240
  v_lshlrev_b32 v44, 4, v2
  v_lshl_add_u32 v44, v3, 15, v44
  s_lshl_b32 s34, s4, 10
  s_lshl_b32 s35, s5, 8
  s_add_u32 s34, s34, s35
  s_add_u32 s34, s34, 393216
  s_lshl_b32 s35, s4, 2
  s_add_u32 s35, s35, s5
  s_lshl_b32 s35, s35, 4
  s_add_u32 s35, s35, 4096
  s_waitcnt lgkmcnt(0)
  v_mfma_f32_16x16x32_bf16 v[144:147], v[96:99], v[64:67], 0
  v_mfma_f32_16x16x32_bf16 v[148:151], v[96:99], v[80:83], 0
  v_mfma_f32_16x16x32_bf16 v[144:147], v[100:103], v[68:71], v[144:147]
  v_mfma_f32_16x16x32_bf16 v[148:151], v[100:103], v[84:87], v[148:151]
  v_mfma_f32_16x16x32_bf16 v[144:147], v[104:107], v[72:75], v[144:147]
  v_mfma_f32_16x16x32_bf16 v[148:151], v[104:107], v[88:91], v[148:151]
  v_mfma_f32_16x16x32_bf16 v[144:147], v[108:111], v[76:79], v[144:147]
  v_mfma_f32_16x16x32_bf16 v[148:151], v[108:111], v[92:95], v[148:151]
  s_nop 8
  v_cndmask_b32 v40, v144, v148, s[44:45]
  v_cndmask_b32 v41, v145, v149, s[44:45]
  v_cndmask_b32 v40, v40, v41, s[46:47]
  v_mul_f32 v40, 0x3e0293ee, v40
  v_cvt_pk_bf16_f32 v54, v40, v40
  ds_write_b16 v56, v54 offset:4096
  s_waitcnt lgkmcnt(0)
  s_barrier
  s_cmp_lg_u32 s3, 0
  s_cbranch_scc1 L_nopub_10
  ds_read_b128 v[40:43], v4 offset:4096
  v_mov_b32 v46, s6
  v_mov_b32 v47, s6
  v_lshlrev_b32 v45, 11, v1
  s_waitcnt lgkmcnt(0)
  s_mov_b32 exec_lo, -1
  s_mov_b32 exec_hi, 0
  buffer_store_dwordx4 v[40:43], v44, s[8:11], s34 offen sc1
  s_mov_b64 exec, 0xff
  s_waitcnt vmcnt(0)
  buffer_store_dwordx2 v[46:47], v45, s[8:11], s35 offen sc1
  s_mov_b64 exec, -1
L_nopub_10:
  s_barrier
  s_mov_b32 s24, s66
  s_and_b32 s25, s67, 0xffff
  s_mov_b32 s26, 16777216
  s_mov_b32 s27, 0x20000
  s_add_u32 s30, s3, 1
  s_mul_i32 s30, s30, 32
  s_sub_u32 s28, s3, 1
  s_mul_i32 s28, s28, 32
  s_add_u32 s28, s28, 64
  s_cmp_lt_u32 s3, 2
  s_cselect_b32 s30, s30, s28
  s_lshl_b32 s29, s2, 7
  s_add_u32 s29, s29, s30
  s_lshl_b32 s29, s29, 10
  s_lshl_b32 s31, s3, 10
  s_add_u32 m0, s31, 155648
  s_sub_u32 s30, s29, 1024
  buffer_load_dwordx4 v4, s[24:27], s30 offen lds
  s_sub_u32 s30, s29, 2048
  buffer_load_dwordx4 v4, s[24:27], s30 offen lds
  s_sub_u32 s30, s29, 3072
  buffer_load_dwordx4 v4, s[24:27], s30 offen lds
  s_sub_u32 s30, s29, 4096
  buffer_load_dwordx4 v4, s[24:27], s30 offen lds
  s_sub_u32 s30, s29, 5120
  buffer_load_dwordx4 v4, s[24:27], s30 offen lds
  s_sub_u32 s30, s29, 6144
  buffer_load_dwordx4 v4, s[24:27], s30 offen lds
  s_sub_u32 s30, s29, 7168
  buffer_load_dwordx4 v4, s[24:27], s30 offen lds
  s_sub_u32 s30, s29, 8192
  buffer_load_dwordx4 v4, s[24:27], s30 offen lds
  s_sub_u32 s30, s29, 9216
  buffer_load_dwordx4 v4, s[24:27], s30 offen lds
  s_sub_u32 s30, s29, 10240
  buffer_load_dwordx4 v4, s[24:27], s30 offen lds
  s_sub_u32 s30, s29, 11264
  buffer_load_dwordx4 v4, s[24:27], s30 offen lds
  s_sub_u32 s30, s29, 12288
  buffer_load_dwordx4 v4, s[24:27], s30 offen lds
  s_sub_u32 s30, s29, 13312
  buffer_load_dwordx4 v4, s[24:27], s30 offen lds
  s_sub_u32 s30, s29, 14336
  buffer_load_dwordx4 v4, s[24:27], s30 offen lds
  s_sub_u32 s30, s29, 15360
  buffer_load_dwordx4 v4, s[24:27], s30 offen lds
  s_sub_u32 s30, s29, 16384
  buffer_load_dwordx4 v4, s[24:27], s30 offen lds
L_pfdone_11:
  s_mov_b32 s12, s72
  s_and_b32 s13, s73, 0xffff
  s_mov_b32 s14, 4194304
  s_mov_b32 s15, 0x20000
  s_mov_b32 s16, s74
  s_and_b32 s17, s75, 0xffff
  s_mov_b32 s18, 4194304
  s_mov_b32 s19, 0x20000
  v_lshl_add_u32 v58, v3, 17, v5
  v_xor_b32 v59, 128, v58
  s_lshl_b32 s29, s5, 7
  s_lshl_b32 s28, s3, 2
  s_add_u32 s29, s29, s28
  s_lshl_b32 s29, s29, 13
  s_lshl_b32 s28, s4, 8
  s_add_u32 s29, s29, s28
  s_lshl_b32 s31, s3, 13
  s_mov_b32 s30, s29
  s_add_u32 m0, s31, 8192
  s_nop 0
  buffer_load_dwordx4 v58, s[12:15], s30 offen nt lds
  s_add_u32 s30, s29, 524288
  s_add_u32 m0, s31, 9216
  s_nop 0
  buffer_load_dwordx4 v58, s[12:15], s30 offen nt lds
  s_add_u32 s30, s29, 8192
  s_add_u32 m0, s31, 10240
  s_nop 0
  buffer_load_dwordx4 v59, s[12:15], s30 offen nt lds
  s_add_u32 s30, s29, 532480
  s_add_u32 m0, s31, 11264
  s_nop 0
  buffer_load_dwordx4 v59, s[12:15], s30 offen nt lds
  s_add_u32 s30, s29, 16384
  s_add_u32 m0, s31, 12288
  s_nop 0
  buffer_load_dwordx4 v58, s[12:15], s30 offen nt lds
  s_add_u32 s30, s29, 540672
  s_add_u32 m0, s31, 13312
  s_nop 0
  buffer_load_dwordx4 v58, s[12:15], s30 offen nt lds
  s_add_u32 s30, s29, 24576
  s_add_u32 m0, s31, 14336
  s_nop 0
  buffer_load_dwordx4 v59, s[12:15], s30 offen nt lds
  s_add_u32 s30, s29, 548864
  s_add_u32 m0, s31, 15360
  s_nop 0
  buffer_load_dwordx4 v59, s[12:15], s30 offen nt lds
  v_lshl_add_u32 v58, v3, 10, v5
  v_xor_b32 v59, 128, v58
  s_lshl_b32 s29, s4, 7
  s_lshl_b32 s28, s3, 5
  s_add_u32 s29, s29, s28
  s_lshl_b32 s29, s29, 10
  s_lshl_b32 s28, s5, 8
  s_add_u32 s29, s29, s28
  s_lshl_b32 s31, s3, 13
  s_mov_b32 s30, s29
  s_add_u32 m0, s31, 73728
  s_nop 0
  buffer_load_dwordx4 v58, s[16:19], s30 offen nt lds
  s_add_u32 s30, s29, 4096
  s_add_u32 m0, s31, 74752
  s_nop 0
  buffer_load_dwordx4 v58, s[16:19], s30 offen nt lds
  s_add_u32 s30, s29, 8192
  s_add_u32 m0, s31, 75776
  s_nop 0
  buffer_load_dwordx4 v59, s[16:19], s30 offen nt lds
  s_add_u32 s30, s29, 12288
  s_add_u32 m0, s31, 76800
  s_nop 0
  buffer_load_dwordx4 v59, s[16:19], s30 offen nt lds
  s_add_u32 s30, s29, 16384
  s_add_u32 m0, s31, 77824
  s_nop 0
  buffer_load_dwordx4 v58, s[16:19], s30 offen nt lds
  s_add_u32 s30, s29, 20480
  s_add_u32 m0, s31, 78848
  s_nop 0
  buffer_load_dwordx4 v58, s[16:19], s30 offen nt lds
  s_add_u32 s30, s29, 24576
  s_add_u32 m0, s31, 79872
  s_nop 0
  buffer_load_dwordx4 v59, s[16:19], s30 offen nt lds
  s_add_u32 s30, s29, 28672
  s_add_u32 m0, s31, 80896
  s_nop 0
  buffer_load_dwordx4 v59, s[16:19], s30 offen nt lds
  s_lshr_b32 s28, s2, 4
  s_and_b32 s29, s2, 7
  s_lshl_b32 s30, s29, 3
  s_add_u32 s30, s30, s28
  s_mov_b32 s50, 63
  s_cmp_lt_u32 s29, 4
  s_cselect_b32 s50, s30, s50
  s_add_u32 s30, s28, 32
  s_cmp_lt_u32 s28, 6
  s_cselect_b32 s30, s30, 63
  s_cmp_eq_u32 s29, 6
  s_cselect_b32 s50, s30, s50
  s_add_u32 s30, s28, 38
  s_cmp_eq_u32 s29, 7
  s_cselect_b32 s50, s30, s50
  s_bfe_u32 s51, s2, 0x10003
  s_cmp_ge_u32 s50, 43
  s_cbranch_scc1 L_noffn1_12
  s_mov_b32 s12, s78
  s_and_b32 s13, s79, 0xffff
  s_mov_b32 s14, 1409024
  s_mov_b32 s15, 0x20000
  s_mov_b32 s16, s80
  s_and_b32 s17, s81, 0xffff
  s_mov_b32 s18, 1409024
  s_mov_b32 s19, 0x20000
  s_mov_b32 s20, s82
  s_and_b32 s21, s83, 0xffff
  s_mov_b32 s22, 1409024
  s_mov_b32 s23, 0x20000
  v_lshrrev_b32 v64, 2, v1
  v_mul_u32_u24 v64, 2752, v64
  v_lshrrev_b32 v65, 5, v1
  v_lshlrev_b32 v66, 1, v65
  v_and_b32 v67, 3, v1
  v_xor_b32 v67, v66, v67
  v_lshl_add_u32 v64, v67, 4, v64
  s_lshl_b32 s29, s51, 2
  s_add_u32 s29, s29, s3
  s_mul_i32 s29, s29, 176128
  s_lshl_b32 s28, s50, 6
  s_add_u32 s29, s29, s28
  s_lshl_b32 s31, s3, 12
  s_mov_b32 s30, s29
  s_add_u32 m0, s31, 106496
  s_nop 0
  buffer_load_dwordx4 v64, s[12:15], s30 offen lds
  s_add_u32 s30, s29, 44032
  s_add_u32 m0, s31, 107520
  s_nop 0
  buffer_load_dwordx4 v64, s[12:15], s30 offen lds
  s_add_u32 s30, s29, 88064
  s_add_u32 m0, s31, 108544
  s_nop 0
  buffer_load_dwordx4 v64, s[12:15], s30 offen lds
  s_add_u32 s30, s29, 132096
  s_add_u32 m0, s31, 109568
  s_nop 0
  buffer_load_dwordx4 v64, s[12:15], s30 offen lds
  s_mov_b32 s30, s29
  s_add_u32 m0, s31, 122880
  s_nop 0
  buffer_load_dwordx4 v64, s[16:19], s30 offen lds
  s_add_u32 s30, s29, 44032
  s_add_u32 m0, s31, 123904
  s_nop 0
  buffer_load_dwordx4 v64, s[16:19], s30 offen lds
  s_add_u32 s30, s29, 88064
  s_add_u32 m0, s31, 124928
  s_nop 0
  buffer_load_dwordx4 v64, s[16:19], s30 offen lds
  s_add_u32 s30, s29, 132096
  s_add_u32 m0, s31, 125952
  s_nop 0
  buffer_load_dwordx4 v64, s[16:19], s30 offen lds
  v_and_b32 v67, 31, v1
  v_xor_b32 v67, v67, v66
  s_and_b32 s28, s3, 1
  s_lshl_b32 s28, s28, 3
  v_xor_b32 v67, s28, v67
  v_lshlrev_b32 v67, 4, v67
  v_lshl_add_u32 v67, v65, 10, v67
  v_xor_b32 v68, 64, v67
  s_lshl_b32 s29, s50, 5
  s_lshl_b32 s28, s3, 3
  s_add_u32 s29, s29, s28
  s_lshl_b32 s29, s29, 10
  s_lshl_b32 s28, s51, 9
  s_add_u32 s29, s29, s28
  s_mov_b32 s30, s29
  s_add_u32 m0, s31, 139264
  s_nop 0
  buffer_load_dwordx4 v67, s[20:23], s30 offen nt lds
  s_add_u32 s30, s29, 2048
  s_add_u32 m0, s31, 140288
  s_nop 0
  buffer_load_dwordx4 v68, s[20:23], s30 offen nt lds
  s_add_u32 s30, s29, 4096
  s_add_u32 m0, s31, 141312
  s_nop 0
  buffer_load_dwordx4 v67, s[20:23], s30 offen nt lds
  s_add_u32 s30, s29, 6144
  s_add_u32 m0, s31, 142336
  s_nop 0
  buffer_load_dwordx4 v68, s[20:23], s30 offen nt lds
L_noffn1_12:
  s_lshl_b32 s28, s5, 7
  s_lshr_b32 s29, s3, 1
  s_lshl_b32 s29, s29, 6
  s_add_u32 s28, s28, s29
  s_lshl_b32 s38, s28, 9
  s_lshl_b32 s29, s4, 4
  s_add_u32 s38, s38, s29
  s_add_u32 s38, s38, 1376256
  v_lshlrev_b32 v52, 9, v1
  s_and_b32 s34, s63, 7
  s_lshl_b32 s34, s34, 13
  s_lshl_b32 s28, s5, 11
  s_add_u32 s34, s34, s28
  s_add_u32 s34, s34, 1900544
  s_add_u32 s28, s32, 6291456
  buffer_load_dwordx4 v[232:235], v4, s[8:11], s28 offen sc1
  buffer_load_dwordx4 v[236:239], v4, s[8:11], s28 offen offset:1024 sc1
  s_cmp_ge_u32 s62, 32
  s_cbranch_scc1 L_nowarm_13
  s_mov_b32 s28, s62
  s_lshl_b32 s28, s28, 13
  s_add_u32 s28, s28, 720896
  v_lshlrev_b32 v20, 4, v0
  v_add_u32 v24, 4096, v20
  buffer_load_dwordx4 v[244:247], v20, s[8:11], s28 offen sc1
  buffer_load_dwordx4 v[248:251], v24, s[8:11], s28 offen sc1
L_nowarm_13:
  v_lshl_add_u32 v58, v3, 15, v5
  v_xor_b32 v59, 128, v58
  s_lshl_b32 s29, s3, 7
  s_add_u32 s29, s29, s5
  s_lshl_b32 s29, s29, 13
  s_lshl_b32 s28, s4, 8
  s_add_u32 s29, s29, s28
  s_add_u32 s29, s29, 2097152
  v_lshlrev_b32 v53, 4, v2
  v_lshl_add_u32 v53, v3, 13, v53
  s_lshl_b32 s28, s5, 2
  s_add_u32 s28, s28, s3
  s_lshl_b32 s28, s28, 14
  s_lshl_b32 s39, s4, 8
  s_add_u32 s28, s28, s39
  s_add_u32 s39, s28, 720896
  v_add_u32 v21, 40960, v6
  v_add_u32 v22, 40960, v7
  s_cmp_ge_u32 s50, 43
  s_cbranch_scc1 L_w1_14
  s_waitcnt vmcnt(14)
  s_branch L_w2_15
L_w1_14:
  s_waitcnt vmcnt(0)
L_w2_15:
  s_barrier
  ds_read_b64_tr_b16 v[160:161], v6 offset:8192
  ds_read_b64_tr_b16 v[162:163], v6 offset:9216
  ds_read_b64_tr_b16 v[176:177], v7 offset:8192
  ds_read_b64_tr_b16 v[178:179], v7 offset:9216
  ds_read_b64_tr_b16 v[164:165], v6 offset:16384
  ds_read_b64_tr_b16 v[166:167], v6 offset:17408
  ds_read_b64_tr_b16 v[180:181], v7 offset:16384
  ds_read_b64_tr_b16 v[182:183], v7 offset:17408
  ds_read_b64_tr_b16 v[168:169], v6 offset:24576
  ds_read_b64_tr_b16 v[170:171], v6 offset:25600
  ds_read_b64_tr_b16 v[184:185], v7 offset:24576
  ds_read_b64_tr_b16 v[186:187], v7 offset:25600
  ds_read_b64_tr_b16 v[172:173], v6 offset:32768
  ds_read_b64_tr_b16 v[174:175], v6 offset:33792
  ds_read_b64_tr_b16 v[188:189], v7 offset:32768
  ds_read_b64_tr_b16 v[190:191], v7 offset:33792
  v_add_u32 v25, 73728, v6
  v_add_u32 v26, 73728, v7
  ds_read_b64_tr_b16 v[192:193], v25 offset:0
  ds_read_b64_tr_b16 v[194:195], v25 offset:1024
  ds_read_b64_tr_b16 v[208:209], v26 offset:0
  ds_read_b64_tr_b16 v[210:211], v26 offset:1024
  ds_read_b64_tr_b16 v[196:197], v25 offset:8192
  ds_read_b64_tr_b16 v[198:199], v25 offset:9216
  ds_read_b64_tr_b16 v[212:213], v26 offset:8192
  ds_read_b64_tr_b16 v[214:215], v26 offset:9216
  ds_read_b64_tr_b16 v[200:201], v25 offset:16384
  ds_read_b64_tr_b16 v[202:203], v25 offset:17408
  ds_read_b64_tr_b16 v[216:217], v26 offset:16384
  ds_read_b64_tr_b16 v[218:219], v26 offset:17408
  ds_read_b64_tr_b16 v[204:205], v25 offset:24576
  ds_read_b64_tr_b16 v[206:207], v25 offset:25600
  ds_read_b64_tr_b16 v[220:221], v26 offset:24576
  ds_read_b64_tr_b16 v[222:223], v26 offset:25600
  s_mov_b32 s56, s34
  s_mov_b32 s57, s35
  s_mov_b32 s58, s36
  s_mov_b32 s59, s37
  s_mov_b32 s60, s29
  v_mov_b32 v69, v20
  v_mov_b32 v70, v21
  v_mov_b32 v71, v22
  v_mov_b32 v72, v24
  s_cmp_ge_u32 s50, 43
  s_cbranch_scc1 L_noffn2_16
  v_bfe_u32 v17, v1, 2, 2
  v_and_b32 v18, 3, v1
  v_and_b32 v19, 1, v3
  s_and_b32 s28, s3, 1
  s_lshl_b32 s28, s28, 1
  v_lshrrev_b32 v20, 1, v18
  v_add_u32 v20, s28, v20
  v_lshlrev_b32 v21, 1, v19
  v_xor_b32 v20, v20, v21
  v_lshlrev_b32 v20, 4, v20
  v_and_b32 v21, 1, v18
  v_lshl_add_u32 v20, v21, 3, v20
  v_lshl_add_u32 v21, v3, 3, v17
  v_lshl_add_u32 v20, v21, 6, v20
  s_lshr_b32 s28, s3, 1
  s_lshl_b32 s28, s28, 14
  s_add_u32 s28, s28, 106496
  v_add_u32 v20, s28, v20
  v_and_b32 v21, 1, v1
  v_lshlrev_b32 v21, 10, v21
  v_lshl_add_u32 v21, v3, 4, v21
  s_lshl_b32 s28, s51, 9
  v_add_u32 v21, s28, v21
  s_lshl_b32 s28, s2, 2
  s_add_u32 s28, s28, s3
  s_lshl_b32 s28, s28, 8
  s_add_u32 s34, s28, 6684672
  s_add_u32 s35, s28, 6553600
  s_xor_b32 s28, s2, 8
  s_lshl_b32 s28, s28, 2
  s_add_u32 s28, s28, s3
  s_lshl_b32 s28, s28, 8
  s_add_u32 s36, s28, 6684672
  s_add_u32 s37, s28, 6553600
  v_lshlrev_b32 v26, 4, v2
  v_mov_b32 v41, s6
  v_mov_b32 v43, s6
  buffer_load_dwordx4 v[232:235], v26, s[8:11], s37 offen sc1
  s_waitcnt vmcnt(7)
  s_barrier
  ds_read_b128 v[96:99], v21 offset:0
  ds_read_b64_tr_b16 v[128:129], v20 offset:0
  ds_read_b64_tr_b16 v[130:131], v20 offset:256
  ds_read_b128 v[100:103], v21 offset:64
  ds_read_b64_tr_b16 v[132:133], v20 offset:2048
  ds_read_b64_tr_b16 v[134:135], v20 offset:2304
  ds_read_b128 v[104:107], v21 offset:128
  ds_read_b64_tr_b16 v[136:137], v20 offset:4096
  ds_read_b64_tr_b16 v[138:139], v20 offset:4352
  ds_read_b128 v[108:111], v21 offset:192
  ds_read_b64_tr_b16 v[140:141], v20 offset:6144
  ds_read_b64_tr_b16 v[142:143], v20 offset:6400
  ds_read_b128 v[112:115], v21 offset:256
  ds_read_b64_tr_b16 v[144:145], v20 offset:8192
  ds_read_b64_tr_b16 v[146:147], v20 offset:8448
  ds_read_b128 v[116:119], v21 offset:320
  ds_read_b64_tr_b16 v[148:149], v20 offset:10240
  ds_read_b64_tr_b16 v[150:151], v20 offset:10496
  ds_read_b128 v[120:123], v21 offset:384
  ds_read_b64_tr_b16 v[152:153], v20 offset:12288
  ds_read_b64_tr_b16 v[154:155], v20 offset:12544
  ds_read_b128 v[124:127], v21 offset:448
  ds_read_b64_tr_b16 v[156:157], v20 offset:14336
  ds_read_b64_tr_b16 v[158:159], v20 offset:14592
  s_waitcnt lgkmcnt(0)
  v_mfma_f32_16x16x32_bf16 v[76:79], v[96:99], v[128:131], 0
  v_mfma_f32_16x16x32_bf16 v[76:79], v[100:103], v[132:135], v[76:79]
  v_mfma_f32_16x16x32_bf16 v[76:79], v[104:107], v[136:139], v[76:79]
  v_mfma_f32_16x16x32_bf16 v[76:79], v[108:111], v[140:143], v[76:79]
  v_mfma_f32_16x16x32_bf16 v[76:79], v[112:115], v[144:147], v[76:79]
  v_mfma_f32_16x16x32_bf16 v[76:79], v[116:119], v[148:151], v[76:79]
  v_mfma_f32_16x16x32_bf16 v[76:79], v[120:123], v[152:155], v[76:79]
  v_mfma_f32_16x16x32_bf16 v[76:79], v[124:127], v[156:159], v[76:79]
  v_lshl_add_u32 v20, v19, 2, v17
  v_lshlrev_b32 v20, 1, v20
  s_lshl_b32 s28, s3, 3
  v_xor_b32 v20, s28, v20
  v_lshl_add_u32 v21, v3, 3, v17
  v_lshlrev_b32 v21, 9, v21
  v_lshrrev_b32 v22, 1, v18
  v_lshl_add_u32 v21, v22, 4, v21
  v_and_b32 v22, 1, v18
  v_lshl_add_u32 v21, v22, 3, v21
  v_add_u32 v21, 139264, v21
  v_xor_b32 v22, 0, v20
  v_lshl_add_u32 v28, v22, 4, v21
  v_xor_b32 v22, 2, v20
  v_lshl_add_u32 v29, v22, 4, v21
  v_xor_b32 v22, 4, v20
  v_lshl_add_u32 v30, v22, 4, v21
  v_xor_b32 v22, 6, v20
  v_lshl_add_u32 v31, v22, 4, v21
  v_mov_b32 v40, v76
  v_mov_b32 v42, v77
  s_mov_b64 exec, 0xffff
  buffer_store_dwordx4 v[40:43], v26, s[8:11], s35 offen
  s_mov_b64 exec, -1
  s_mov_b32 s49, 24
  buffer_load_dwordx4 v[224:227], v26, s[8:11], s37 offen sc1
L_fp_17:
  buffer_load_dwordx4 v[228:231], v26, s[8:11], s37 offen sc1
  s_waitcnt vmcnt(1)
  v_xor_b32 v61, s6, v225
  v_xor_b32 v62, s6, v227
  v_or_b32 v60, v61, v62
  v_cmp_ne_u32 vcc, 0, v60
  s_cbranch_vccz L_fx0_18
  buffer_load_dwordx4 v[224:227], v26, s[8:11], s37 offen sc1
  s_waitcnt vmcnt(1)
  v_xor_b32 v61, s6, v229
  v_xor_b32 v62, s6, v231
  v_or_b32 v60, v61, v62
  v_cmp_ne_u32 vcc, 0, v60
  s_cbranch_vccz L_fx1_19
  s_sub_u32 s49, s49, 1
  s_cbranch_scc0 L_fp_17
  s_mov_b64 exec, 0xffff
  buffer_store_dwordx4 v[40:43], v26, s[8:11], s34 offen sc1
  s_mov_b64 exec, -1
  s_mov_b32 s48, 200000
  buffer_load_dwordx4 v[224:227], v26, s[8:11], s37 offen sc1
  s_sleep 1
  buffer_load_dwordx4 v[228:231], v26, s[8:11], s36 offen sc1
  s_sleep 1
L_poll_21:
  buffer_load_dwordx4 v[232:235], v26, s[8:11], s37 offen sc1
  s_waitcnt vmcnt(2)
  v_xor_b32 v61, s6, v225
  v_xor_b32 v62, s6, v227
  v_or_b32 v60, v61, v62
  v_cmp_ne_u32 vcc, 0, v60
  s_cbranch_vccz L_pexit_23
  s_sleep 1
  buffer_load_dwordx4 v[224:227], v26, s[8:11], s37 offen sc1
  s_waitcnt vmcnt(2)
  v_xor_b32 v61, s6, v229
  v_xor_b32 v62, s6, v231
  v_or_b32 v60, v61, v62
  v_cmp_ne_u32 vcc, 0, v60
  s_cbranch_vccz L_pexit_24
  s_sleep 1
  buffer_load_dwordx4 v[228:231], v26, s[8:11], s36 offen sc1
  s_waitcnt vmcnt(2)
  v_xor_b32 v61, s6, v233
  v_xor_b32 v62, s6, v235
  v_or_b32 v60, v61, v62
  v_cmp_ne_u32 vcc, 0, v60
  s_cbranch_vccz L_pexit_25
  s_sleep 1
  s_sub_u32 s48, s48, 1
  s_cbranch_scc0 L_poll_21
L_pexit_23:
  v_mov_b32 v44, v224
  v_mov_b32 v45, v225
  v_mov_b32 v46, v226
  v_mov_b32 v47, v227
  s_branch L_pdone_22
L_pexit_24:
  v_mov_b32 v44, v228
  v_mov_b32 v45, v229
  v_mov_b32 v46, v230
  v_mov_b32 v47, v231
  s_branch L_pdone_22
L_pexit_25:
  v_mov_b32 v44, v232
  v_mov_b32 v45, v233
  v_mov_b32 v46, v234
  v_mov_b32 v47, v235
L_pdone_22:
  s_branch L_fdone_20
L_fx0_18:
  v_mov_b32 v44, v224
  v_mov_b32 v45, v225
  v_mov_b32 v46, v226
  v_mov_b32 v47, v227
  s_mov_b64 exec, 0xffff
  buffer_store_dwordx4 v[40:43], v26, s[8:11], s34 offen sc1
  s_mov_b64 exec, -1
  s_branch L_fdone_20
L_fx1_19:
  v_mov_b32 v44, v228
  v_mov_b32 v45, v229
  v_mov_b32 v46, v230
  v_mov_b32 v47, v231
  s_mov_b64 exec, 0xffff
  buffer_store_dwordx4 v[40:43], v26, s[8:11], s34 offen sc1
  s_mov_b64 exec, -1
L_fdone_20:
  v_add_f32 v76, v76, v44
  v_add_f32 v77, v77, v46
  v_and_b32 v23, 1, v3
  v_lshlrev_b32 v23, 7, v23
  v_lshl_add_u32 v23, v2, 2, v23
  v_cndmask_b32 v22, v76, v77, s[44:45]
  s_lshr_b32 s28, s3, 1
  s_lshl_b32 s28, s28, 8
  s_and_b32 s29, s3, 1
  s_lshl_b32 s29, s29, 6
  s_add_u32 s28, s28, s29
  v_add_u32 v23, s28, v23
  ds_write_b32 v23, v22 offset:5120
  s_waitcnt lgkmcnt(0)
  s_barrier
  v_lshlrev_b32 v23, 2, v1
  ds_read_b32 v24, v23 offset:5120
  ds_read_b32 v25, v23 offset:5376
  ds_read_b64_tr_b16 v[128:129], v28 offset:0
  ds_read_b64_tr_b16 v[130:131], v28 offset:2048
  ds_read_b64_tr_b16 v[132:133], v29 offset:0
  ds_read_b64_tr_b16 v[134:135], v29 offset:2048
  ds_read_b64_tr_b16 v[136:137], v30 offset:0
  ds_read_b64_tr_b16 v[138:139], v30 offset:2048
  ds_read_b64_tr_b16 v[140:141], v31 offset:0
  ds_read_b64_tr_b16 v[142:143], v31 offset:2048
  v_mul_u32_u24 v20, 12288, v3
  v_lshl_add_u32 v20, v2, 4, v20
  s_lshl_b32 s28, s51, 2
  s_add_u32 s28, s28, s3
  s_mul_i32 s28, s28, 49152
  s_lshl_b32 s29, s50, 8
  s_add_u32 s28, s28, s29
  s_add_u32 s28, s28, 983040
  s_waitcnt lgkmcnt(8)
  v_cvt_pk_bf16_f32 v24, v24, v24
  v_lshlrev_b32 v24, 16, v24
  v_cvt_pk_bf16_f32 v25, v25, v25
  v_lshlrev_b32 v25, 16, v25
  v_mul_f32 v26, 0xbfb8aa3b, v24
  v_exp_f32 v26, v26
  v_lshlrev_b32 v23, 1, v1
  v_add_f32 v26, 1.0, v26
  v_rcp_f32 v26, v26
  v_and_b32 v21, 1, v1
  v_mul_f32 v26, v24, v26
  v_cvt_pk_bf16_f32 v26, v26, v26
  v_lshlrev_b32 v26, 16, v26
  v_mul_f32 v26, v26, v25
  v_cvt_pk_bf16_f32 v26, v26, v26
  ds_write_b16 v23, v26 offset:5632
  v_lshlrev_b32 v21, 6, v21
  v_lshl_add_u32 v21, v3, 4, v21
  s_waitcnt lgkmcnt(0)
  ds_read_b128 v[96:99], v21 offset:5632
  v_mov_b32 v37, s6
  v_mov_b32 v39, s6
  s_waitcnt lgkmcnt(0)
  v_mfma_f32_16x16x32_bf16 v[100:103], v[96:99], v[128:131], 0
  v_mfma_f32_16x16x32_bf16 v[104:107], v[96:99], v[132:135], 0
  v_mfma_f32_16x16x32_bf16 v[108:111], v[96:99], v[136:139], 0
  v_mfma_f32_16x16x32_bf16 v[112:115], v[96:99], v[140:143], 0
  s_nop 8
  v_cndmask_b32 v32, v100, v104, s[44:45]
  v_cndmask_b32 v33, v108, v112, s[44:45]
  v_cndmask_b32 v36, v32, v33, s[46:47]
  v_cndmask_b32 v32, v101, v105, s[44:45]
  v_cndmask_b32 v33, v109, v113, s[44:45]
  v_cndmask_b32 v38, v32, v33, s[46:47]
  buffer_store_dwordx4 v[36:39], v20, s[8:11], s28 offen sc1
L_noffn2_16:
  s_mov_b32 s34, s56
  s_mov_b32 s35, s57
  s_mov_b32 s36, s58
  s_mov_b32 s37, s59
  s_mov_b32 s29, s60
  v_mov_b32 v20, v69
  v_mov_b32 v21, v70
  v_mov_b32 v22, v71
  v_mov_b32 v24, v72
  s_cmp_lg_u32 s3, 0
  s_cbranch_scc1 L_codd_26
  s_mov_b32 s48, 200000
  buffer_load_dwordx2 v[224:225], v4, s[8:11], s34 offen sc1
  buffer_load_dwordx2 v[226:227], v4, s[8:11], s34 offen offset:1024 sc1
  s_sleep 4
  buffer_load_dwordx2 v[228:229], v4, s[8:11], s34 offen sc1
  buffer_load_dwordx2 v[230:231], v4, s[8:11], s34 offen offset:1024 sc1
  s_sleep 4
L_poll_28:
  buffer_load_dwordx2 v[232:233], v4, s[8:11], s34 offen sc1
  buffer_load_dwordx2 v[234:235], v4, s[8:11], s34 offen offset:1024 sc1
  s_waitcnt vmcnt(4)
  v_xor_b32 v61, s6, v224
  v_xor_b32 v62, s6, v225
  v_or_b32 v60, v61, v62
  v_xor_b32 v61, s6, v226
  v_xor_b32 v62, s6, v227
  v_or3_b32 v60, v60, v61, v62
  v_cmp_ne_u32 vcc, 0, v60
  s_cbranch_vccz L_pexit_30
  s_sleep 4
  buffer_load_dwordx2 v[224:225], v4, s[8:11], s34 offen sc1
  buffer_load_dwordx2 v[226:227], v4, s[8:11], s34 offen offset:1024 sc1
  s_waitcnt vmcnt(4)
  v_xor_b32 v61, s6, v228
  v_xor_b32 v62, s6, v229
  v_or_b32 v60, v61, v62
  v_xor_b32 v61, s6, v230
  v_xor_b32 v62, s6, v231
  v_or3_b32 v60, v60, v61, v62
  v_cmp_ne_u32 vcc, 0, v60
  s_cbranch_vccz L_pexit_31
  s_sleep 4
  buffer_load_dwordx2 v[228:229], v4, s[8:11], s34 offen sc1
  buffer_load_dwordx2 v[230:231], v4, s[8:11], s34 offen offset:1024 sc1
  s_waitcnt vmcnt(4)
  v_xor_b32 v61, s6, v232
  v_xor_b32 v62, s6, v233
  v_or_b32 v60, v61, v62
  v_xor_b32 v61, s6, v234
  v_xor_b32 v62, s6, v235
  v_or3_b32 v60, v60, v61, v62
  v_cmp_ne_u32 vcc, 0, v60
  s_cbranch_vccz L_pexit_32
  s_sleep 4
  s_sub_u32 s48, s48, 1
  s_cbranch_scc0 L_poll_28
L_pexit_30:
  v_mov_b32 v40, v224
  v_mov_b32 v41, v225
  v_mov_b32 v42, v226
  v_mov_b32 v43, v227
  s_branch L_pdone_29
L_pexit_31:
  v_mov_b32 v40, v228
  v_mov_b32 v41, v229
  v_mov_b32 v42, v230
  v_mov_b32 v43, v231
  s_branch L_pdone_29
L_pexit_32:
  v_mov_b32 v40, v232
  v_mov_b32 v41, v233
  v_mov_b32 v42, v234
  v_mov_b32 v43, v235
L_pdone_29:
L_codd_26:
  s_barrier
  buffer_load_dwordx4 v[40:43], v52, s[8:11], s38 offen sc1
  s_lshl_b32 s31, s3, 13
  s_mov_b32 s30, s29
  s_add_u32 m0, s31, 40960
  s_nop 0
  buffer_load_dwordx4 v58, s[8:11], s30 offen sc1 lds
  s_add_u32 s30, s29, 131072
  s_add_u32 m0, s31, 41984
  s_nop 0
  buffer_load_dwordx4 v58, s[8:11], s30 offen sc1 lds
  s_add_u32 s30, s29, 262144
  s_add_u32 m0, s31, 43008
  s_nop 0
  buffer_load_dwordx4 v59, s[8:11], s30 offen sc1 lds
  s_add_u32 s30, s29, 393216
  s_add_u32 m0, s31, 44032
  s_nop 0
  buffer_load_dwordx4 v59, s[8:11], s30 offen sc1 lds
  s_add_u32 s30, s29, 524288
  s_add_u32 m0, s31, 45056
  s_nop 0
  buffer_load_dwordx4 v58, s[8:11], s30 offen sc1 lds
  s_add_u32 s30, s29, 655360
  s_add_u32 m0, s31, 46080
  s_nop 0
  buffer_load_dwordx4 v58, s[8:11], s30 offen sc1 lds
  s_add_u32 s30, s29, 786432
  s_add_u32 m0, s31, 47104
  s_nop 0
  buffer_load_dwordx4 v59, s[8:11], s30 offen sc1 lds
  s_add_u32 s30, s29, 917504
  s_add_u32 m0, s31, 48128
  s_nop 0
  buffer_load_dwordx4 v59, s[8:11], s30 offen sc1 lds
  s_and_b32 s28, s3, 1
  s_cmp_lg_u32 s28, 0
  s_cbranch_scc1 L_cjoin_27
  s_waitcnt vmcnt(8)
  v_mov_b32 v44, v40
  s_nop 1
  v_max_f32_dpp v44, v44, v44 row_ror:8 row_mask:0xf bank_mask:0xf
  s_nop 1
  v_max_f32_dpp v44, v44, v44 row_ror:4 row_mask:0xf bank_mask:0xf
  s_nop 1
  v_max_f32_dpp v44, v44, v44 row_ror:2 row_mask:0xf bank_mask:0xf
  s_nop 1
  v_max_f32_dpp v44, v44, v44 row_ror:1 row_mask:0xf bank_mask:0xf
  v_mov_b32 v45, v44
  s_nop 1
  v_permlane16_swap_b32 v44, v45
  s_nop 0
  v_max_f32 v44, v44, v45
  v_mov_b32 v45, v44
  s_nop 1
  v_permlane32_swap_b32 v44, v45
  s_nop 0
  v_max_f32 v44, v44, v45
  v_sub_f32 v40, v40, v44
  v_exp_f32 v40, v40
  s_nop 0
  v_mul_f32 v44, v40, v42
  s_nop 1
  v_add_f32_dpp v44, v44, v44 row_ror:8 row_mask:0xf bank_mask:0xf
  s_nop 1
  v_add_f32_dpp v44, v44, v44 row_ror:4 row_mask:0xf bank_mask:0xf
  s_nop 1
  v_add_f32_dpp v44, v44, v44 row_ror:2 row_mask:0xf bank_mask:0xf
  s_nop 1
  v_add_f32_dpp v44, v44, v44 row_ror:1 row_mask:0xf bank_mask:0xf
  v_mov_b32 v45, v44
  s_nop 1
  v_permlane16_swap_b32 v44, v45
  s_nop 0
  v_add_f32 v44, v44, v45
  v_mov_b32 v45, v44
  s_nop 1
  v_permlane32_swap_b32 v44, v45
  s_nop 0
  v_add_f32 v44, v44, v45
  v_rcp_f32 v44, v44
  s_lshr_b32 s29, s3, 1
  s_mul_i32 s28, s29, 384
  v_lshlrev_b32 v45, 1, v1
  v_mul_f32 v40, v40, v44
  v_add_u32 v46, s28, v45
  v_cvt_pk_bf16_f32 v40, v40, v40
  s_lshl_b32 s28, s29, 7
  s_add_u32 s28, s28, 128
  ds_write_b16 v46, v40 offset:3584
  v_add_u32 v46, s28, v45
  v_mov_b32 v47, 0
  ds_write_b16 v46, v47 offset:3584
L_cjoin_27:
  s_add_u32 s34, s33, 458752
  s_add_u32 s35, s33, 6291456
  s_waitcnt vmcnt(0) lgkmcnt(0)
  s_barrier
  ds_read_b128 v[96:99], v57 offset:3584
  ds_read_b128 v[100:103], v57 offset:3648
  ds_read_b128 v[104:107], v57 offset:3712
  ds_read_b128 v[108:111], v57 offset:3776
  ds_read_b64_tr_b16 v[112:113], v21 offset:0
  ds_read_b64_tr_b16 v[114:115], v21 offset:1024
  ds_read_b64_tr_b16 v[128:129], v22 offset:0
  ds_read_b64_tr_b16 v[130:131], v22 offset:1024
  ds_read_b64_tr_b16 v[116:117], v21 offset:8192
  ds_read_b64_tr_b16 v[118:119], v21 offset:9216
  ds_read_b64_tr_b16 v[132:133], v22 offset:8192
  ds_read_b64_tr_b16 v[134:135], v22 offset:9216
  ds_read_b64_tr_b16 v[120:121], v21 offset:16384
  ds_read_b64_tr_b16 v[122:123], v21 offset:17408
  ds_read_b64_tr_b16 v[136:137], v22 offset:16384
  ds_read_b64_tr_b16 v[138:139], v22 offset:17408
  ds_read_b64_tr_b16 v[124:125], v21 offset:24576
  ds_read_b64_tr_b16 v[126:127], v21 offset:25600
  ds_read_b64_tr_b16 v[140:141], v22 offset:24576
  ds_read_b64_tr_b16 v[142:143], v22 offset:25600
  s_waitcnt lgkmcnt(0)
  v_mfma_f32_16x16x32_bf16 v[144:147], v[96:99], v[112:115], 0
  v_mfma_f32_16x16x32_bf16 v[148:151], v[96:99], v[128:131], 0
  v_mfma_f32_16x16x32_bf16 v[144:147], v[100:103], v[116:119], v[144:147]
  v_mfma_f32_16x16x32_bf16 v[148:151], v[100:103], v[132:135], v[148:151]
  v_mfma_f32_16x16x32_bf16 v[144:147], v[104:107], v[120:123], v[144:147]
  v_mfma_f32_16x16x32_bf16 v[148:151], v[104:107], v[136:139], v[148:151]
  v_mfma_f32_16x16x32_bf16 v[144:147], v[108:111], v[124:127], v[144:147]
  v_mfma_f32_16x16x32_bf16 v[148:151], v[108:111], v[140:143], v[148:151]
  s_nop 8
  v_cndmask_b32 v40, v144, v148, s[44:45]
  v_cndmask_b32 v41, v145, v149, s[44:45]
  v_cndmask_b32 v40, v40, v41, s[46:47]
  v_cvt_pk_bf16_f32 v54, v40, v40
  ds_write_b16 v56, v54 offset:2560
  s_waitcnt lgkmcnt(0)
  s_barrier
  ds_read_b128 v[96:99], v57 offset:2560
  ds_read_b128 v[100:103], v57 offset:2624
  ds_read_b128 v[104:107], v57 offset:2688
  ds_read_b128 v[108:111], v57 offset:2752
  s_waitcnt lgkmcnt(0)
  v_mfma_f32_16x16x32_bf16 v[144:147], v[96:99], v[160:163], 0
  v_mfma_f32_16x16x32_bf16 v[148:151], v[96:99], v[176:179], 0
  v_mfma_f32_16x16x32_bf16 v[144:147], v[100:103], v[164:167], v[144:147]
  v_mfma_f32_16x16x32_bf16 v[148:151], v[100:103], v[180:183], v[148:151]
  v_mfma_f32_16x16x32_bf16 v[144:147], v[104:107], v[168:171], v[144:147]
  v_mfma_f32_16x16x32_bf16 v[148:151], v[104:107], v[184:187], v[148:151]
  v_mfma_f32_16x16x32_bf16 v[144:147], v[108:111], v[172:175], v[144:147]
  v_mfma_f32_16x16x32_bf16 v[148:151], v[108:111], v[188:191], v[148:151]
  s_nop 8
  v_cndmask_b32 v48, v144, v148, s[44:45]
  v_cndmask_b32 v50, v145, v149, s[44:45]
  s_mov_b32 exec_lo, -1
  s_mov_b32 exec_hi, 0
  buffer_store_dwordx4 v[48:51], v55, s[8:11], s35 offen
  s_mov_b64 exec, -1
  s_mov_b32 s37, s34
  s_add_u32 s34, s32, 458752
  s_add_u32 s35, s32, 6291456
  s_mov_b32 s49, 24
  buffer_load_dwordx4 v[224:227], v4, s[8:11], s35 offen sc1
  buffer_load_dwordx4 v[228:231], v4, s[8:11], s35 offen offset:1024 sc1
L_fp_33:
  buffer_load_dwordx4 v[232:235], v4, s[8:11], s35 offen sc1
  buffer_load_dwordx4 v[236:239], v4, s[8:11], s35 offen offset:1024 sc1
  s_waitcnt vmcnt(2)
  v_xor_b32 v61, s6, v225
  v_xor_b32 v62, s6, v227
  v_or_b32 v60, v61, v62
  v_xor_b32 v61, s6, v229
  v_xor_b32 v62, s6, v231
  v_or3_b32 v60, v60, v61, v62
  v_cmp_ne_u32 vcc, 0, v60
  s_cbranch_vccz L_fx0_34
  buffer_load_dwordx4 v[224:227], v4, s[8:11], s35 offen sc1
  buffer_load_dwordx4 v[228:231], v4, s[8:11], s35 offen offset:1024 sc1
  s_waitcnt vmcnt(2)
  v_xor_b32 v61, s6, v233
  v_xor_b32 v62, s6, v235
  v_or_b32 v60, v61, v62
  v_xor_b32 v61, s6, v237
  v_xor_b32 v62, s6, v239
  v_or3_b32 v60, v60, v61, v62
  v_cmp_ne_u32 vcc, 0, v60
  s_cbranch_vccz L_fx1_35
  s_sub_u32 s49, s49, 1
  s_cbranch_scc0 L_fp_33
  s_mov_b32 exec_lo, -1
  s_mov_b32 exec_hi, 0
  buffer_store_dwordx4 v[48:51], v55, s[8:11], s37 offen sc1
  s_mov_b64 exec, -1
  s_mov_b32 s48, 200000
  buffer_load_dwordx4 v[224:227], v4, s[8:11], s35 offen sc1
  buffer_load_dwordx4 v[228:231], v4, s[8:11], s35 offen offset:1024 sc1
  s_sleep 1
  buffer_load_dwordx4 v[232:235], v4, s[8:11], s34 offen sc1
  buffer_load_dwordx4 v[236:239], v4, s[8:11], s34 offen offset:1024 sc1
  s_sleep 1
L_poll_37:
  buffer_load_dwordx4 v[240:243], v4, s[8:11], s35 offen sc1
  buffer_load_dwordx4 v[244:247], v4, s[8:11], s35 offen offset:1024 sc1
  s_waitcnt vmcnt(4)
  v_xor_b32 v61, s6, v225
  v_xor_b32 v62, s6, v227
  v_or_b32 v60, v61, v62
  v_xor_b32 v61, s6, v229
  v_xor_b32 v62, s6, v231
  v_or3_b32 v60, v60, v61, v62
  v_cmp_ne_u32 vcc, 0, v60
  s_cbranch_vccz L_pexit_39
  s_sleep 1
  buffer_load_dwordx4 v[224:227], v4, s[8:11], s35 offen sc1
  buffer_load_dwordx4 v[228:231], v4, s[8:11], s35 offen offset:1024 sc1
  s_waitcnt vmcnt(4)
  v_xor_b32 v61, s6, v233
  v_xor_b32 v62, s6, v235
  v_or_b32 v60, v61, v62
  v_xor_b32 v61, s6, v237
  v_xor_b32 v62, s6, v239
  v_or3_b32 v60, v60, v61, v62
  v_cmp_ne_u32 vcc, 0, v60
  s_cbranch_vccz L_pexit_40
  s_sleep 1
  buffer_load_dwordx4 v[232:235], v4, s[8:11], s34 offen sc1
  buffer_load_dwordx4 v[236:239], v4, s[8:11], s34 offen offset:1024 sc1
  s_waitcnt vmcnt(4)
  v_xor_b32 v61, s6, v241
  v_xor_b32 v62, s6, v243
  v_or_b32 v60, v61, v62
  v_xor_b32 v61, s6, v245
  v_xor_b32 v62, s6, v247
  v_or3_b32 v60, v60, v61, v62
  v_cmp_ne_u32 vcc, 0, v60
  s_cbranch_vccz L_pexit_41
  s_sleep 1
  s_sub_u32 s48, s48, 1
  s_cbranch_scc0 L_poll_37
L_pexit_39:
  v_mov_b32 v40, v224
  v_mov_b32 v41, v225
  v_mov_b32 v42, v226
  v_mov_b32 v43, v227
  v_mov_b32 v44, v228
  v_mov_b32 v45, v229
  v_mov_b32 v46, v230
  v_mov_b32 v47, v231
  s_branch L_pdone_38
L_pexit_40:
  v_mov_b32 v40, v232
  v_mov_b32 v41, v233
  v_mov_b32 v42, v234
  v_mov_b32 v43, v235
  v_mov_b32 v44, v236
  v_mov_b32 v45, v237
  v_mov_b32 v46, v238
  v_mov_b32 v47, v239
  s_branch L_pdone_38
L_pexit_41:
  v_mov_b32 v40, v240
  v_mov_b32 v41, v241
  v_mov_b32 v42, v242
  v_mov_b32 v43, v243
  v_mov_b32 v44, v244
  v_mov_b32 v45, v245
  v_mov_b32 v46, v246
  v_mov_b32 v47, v247
L_pdone_38:
  s_branch L_fdone_36
L_fx0_34:
  v_mov_b32 v40, v224
  v_mov_b32 v41, v225
  v_mov_b32 v42, v226
  v_mov_b32 v43, v227
  v_mov_b32 v44, v228
  v_mov_b32 v45, v229
  v_mov_b32 v46, v230
  v_mov_b32 v47, v231
  s_mov_b32 exec_lo, -1
  s_mov_b32 exec_hi, 0
  buffer_store_dwordx4 v[48:51], v55, s[8:11], s37 offen sc1
  s_mov_b64 exec, -1
  s_branch L_fdone_36
L_fx1_35:
  v_mov_b32 v40, v232
  v_mov_b32 v41, v233
  v_mov_b32 v42, v234
  v_mov_b32 v43, v235
  v_mov_b32 v44, v236
  v_mov_b32 v45, v237
  v_mov_b32 v46, v238
  v_mov_b32 v47, v239
  s_mov_b32 exec_lo, -1
  s_mov_b32 exec_hi, 0
  buffer_store_dwordx4 v[48:51], v55, s[8:11], s37 offen sc1
  s_mov_b64 exec, -1
L_fdone_36:
  s_nop 0
  v_permlane32_swap_b32 v40, v42
  v_permlane32_swap_b32 v44, v46
  s_nop 0
  v_add_f32 v40, v40, v42
  v_add_f32 v44, v44, v46
  s_nop 1
  v_permlane16_swap_b32 v40, v44
  s_nop 0
  v_add_f32 v40, v40, v44
  v_cvt_pk_bf16_f32 v54, v40, v40
  ds_write_b16 v56, v54 offset:3072
  s_waitcnt lgkmcnt(0)
  s_barrier
  ds_read_b128 v[96:99], v57 offset:3072
  ds_read_b128 v[100:103], v57 offset:3136
  ds_read_b128 v[104:107], v57 offset:3200
  ds_read_b128 v[108:111], v57 offset:3264
  s_waitcnt lgkmcnt(0)
  v_mfma_f32_16x16x32_bf16 v[144:147], v[96:99], v[192:195], 0
  v_mfma_f32_16x16x32_bf16 v[148:151], v[96:99], v[208:211], 0
  v_mfma_f32_16x16x32_bf16 v[144:147], v[100:103], v[196:199], v[144:147]
  v_mfma_f32_16x16x32_bf16 v[148:151], v[100:103], v[212:215], v[148:151]
  v_mfma_f32_16x16x32_bf16 v[144:147], v[104:107], v[200:203], v[144:147]
  v_mfma_f32_16x16x32_bf16 v[148:151], v[104:107], v[216:219], v[148:151]
  v_mfma_f32_16x16x32_bf16 v[144:147], v[108:111], v[204:207], v[144:147]
  v_mfma_f32_16x16x32_bf16 v[148:151], v[108:111], v[220:223], v[148:151]
  s_nop 8
  v_cndmask_b32 v48, v144, v148, s[44:45]
  v_cndmask_b32 v50, v145, v149, s[44:45]
  s_mov_b32 exec_lo, -1
  s_mov_b32 exec_hi, 0
  buffer_store_dwordx4 v[48:51], v53, s[8:11], s39 offen sc1
  s_mov_b64 exec, -1
  s_cmp_ge_u32 s62, 32
  s_cbranch_scc1 L_wdone
  s_mov_b32 s35, s62
  v_lshlrev_b32 v20, 4, v0
  s_lshl_b32 s28, s35, 13
  s_add_u32 s36, s28, 720896
  s_mul_i32 s28, s35, 12288
  s_add_u32 s37, s28, 983040
  s_mov_b32 s12, s64
  s_and_b32 s13, s65, 0xffff
  s_mov_b32 s14, 2048
  s_mov_b32 s15, 0x20000
  v_lshlrev_b32 v21, 10, v3
  v_lshl_add_u32 v21, v2, 1, v21
  s_lshl_b32 s28, s35, 5
  buffer_load_ushort v22, v21, s[12:15], s28 offen
  v_add_u32 v24, 4096, v20
  v_add_u32 v25, 8192, v20
  v_mov_b32 v23, 176
  v_cmp_ge_u32 s[42:43], v0, v23
  v_mov_b32 v26, s6
  v_mov_b32 v27, 0
  buffer_load_dwordx4 v[108:111], v20, s[8:11], s37 offen sc1
  buffer_load_dwordx4 v[112:115], v24, s[8:11], s37 offen sc1
  buffer_load_dwordx4 v[116:119], v25, s[8:11], s37 offen sc1
  s_mov_b32 s48, 200000
  buffer_load_dwordx4 v[224:227], v20, s[8:11], s36 offen sc1
  buffer_load_dwordx4 v[228:231], v24, s[8:11], s36 offen sc1
  s_sleep 1
  buffer_load_dwordx4 v[232:235], v20, s[8:11], s36 offen sc1
  buffer_load_dwordx4 v[236:239], v24, s[8:11], s36 offen sc1
  s_sleep 1
L_poll_42:
  buffer_load_dwordx4 v[240:243], v20, s[8:11], s36 offen sc1
  buffer_load_dwordx4 v[244:247], v24, s[8:11], s36 offen sc1
  s_waitcnt vmcnt(4)
  v_xor_b32 v61, s6, v225
  v_xor_b32 v62, s6, v227
  v_or_b32 v60, v61, v62
  v_xor_b32 v61, s6, v229
  v_xor_b32 v62, s6, v231
  v_or3_b32 v60, v60, v61, v62
  v_cmp_ne_u32 vcc, 0, v60
  s_cbranch_vccz L_pexit_44
  s_sleep 1
  buffer_load_dwordx4 v[224:227], v20, s[8:11], s36 offen sc1
  buffer_load_dwordx4 v[228:231], v24, s[8:11], s36 offen sc1
  s_waitcnt vmcnt(4)
  v_xor_b32 v61, s6, v233
  v_xor_b32 v62, s6, v235
  v_or_b32 v60, v61, v62
  v_xor_b32 v61, s6, v237
  v_xor_b32 v62, s6, v239
  v_or3_b32 v60, v60, v61, v62
  v_cmp_ne_u32 vcc, 0, v60
  s_cbranch_vccz L_pexit_45
  s_sleep 1
  buffer_load_dwordx4 v[232:235], v20, s[8:11], s36 offen sc1
  buffer_load_dwordx4 v[236:239], v24, s[8:11], s36 offen sc1
  s_waitcnt vmcnt(4)
  v_xor_b32 v61, s6, v241
  v_xor_b32 v62, s6, v243
  v_or_b32 v60, v61, v62
  v_xor_b32 v61, s6, v245
  v_xor_b32 v62, s6, v247
  v_or3_b32 v60, v60, v61, v62
  v_cmp_ne_u32 vcc, 0, v60
  s_cbranch_vccz L_pexit_46
  s_sleep 1
  s_sub_u32 s48, s48, 1
  s_cbranch_scc0 L_poll_42
L_pexit_44:
  v_mov_b32 v100, v224
  v_mov_b32 v101, v225
  v_mov_b32 v102, v226
  v_mov_b32 v103, v227
  v_mov_b32 v104, v228
  v_mov_b32 v105, v229
  v_mov_b32 v106, v230
  v_mov_b32 v107, v231
  s_branch L_pdone_43
L_pexit_45:
  v_mov_b32 v100, v232
  v_mov_b32 v101, v233
  v_mov_b32 v102, v234
  v_mov_b32 v103, v235
  v_mov_b32 v104, v236
  v_mov_b32 v105, v237
  v_mov_b32 v106, v238
  v_mov_b32 v107, v239
  s_branch L_pdone_43
L_pexit_46:
  v_mov_b32 v100, v240
  v_mov_b32 v101, v241
  v_mov_b32 v102, v242
  v_mov_b32 v103, v243
  v_mov_b32 v104, v244
  v_mov_b32 v105, v245
  v_mov_b32 v106, v246
  v_mov_b32 v107, v247
L_pdone_43:
  s_mov_b32 s48, 200000
  s_branch L_pfpskip_49
L_pollfp_47:
  buffer_load_dwordx4 v[108:111], v20, s[8:11], s37 offen sc1
  buffer_load_dwordx4 v[112:115], v24, s[8:11], s37 offen sc1
  buffer_load_dwordx4 v[116:119], v25, s[8:11], s37 offen sc1
  s_waitcnt vmcnt(0)
L_pfpskip_49:
  v_cndmask_b32 v117, v117, v26, s[42:43]
  v_cndmask_b32 v119, v119, v26, s[42:43]
  v_xor_b32 v61, s6, v109
  v_xor_b32 v62, s6, v111
  v_or_b32 v60, v61, v62
  v_xor_b32 v61, s6, v113
  v_xor_b32 v62, s6, v115
  v_or3_b32 v60, v60, v61, v62
  v_xor_b32 v61, s6, v117
  v_xor_b32 v62, s6, v119
  v_or3_b32 v60, v60, v61, v62
  v_cmp_ne_u32 vcc, 0, v60
  s_cbranch_vccz L_pfpdone_48
  s_sub_u32 s48, s48, 1
  s_cbranch_scc0 L_pollfp_47
L_pfpdone_48:
  v_cndmask_b32 v116, v116, v27, s[42:43]
  v_cndmask_b32 v118, v118, v27, s[42:43]
  v_add_f32 v100, v100, v104
  v_add_f32 v108, v108, v112
  v_add_f32 v102, v102, v106
  v_add_f32 v110, v110, v114
  v_add_f32 v100, v100, v116
  v_add_f32 v102, v102, v118
  v_add_f32 v100, v100, v108
  v_add_f32 v102, v102, v110
  s_nop 1
  v_permlane32_swap_b32 v100, v102
  s_nop 0
  v_add_f32 v100, v100, v102
  v_mov_b32 v101, v100
  s_nop 1
  v_permlane16_swap_b32 v100, v101
  v_lshrrev_b32 v27, 5, v1
  v_add_f32 v100, v100, v101
  v_lshlrev_b32 v27, 6, v27
  v_lshl_add_u32 v27, v2, 2, v27
  s_lshl_b32 s28, s3, 7
  v_add_u32 v28, s28, v27
  ds_write_b32 v28, v100 offset:4608
  s_mov_b32 s16, s84
  s_and_b32 s17, s85, 0xffff
  s_mov_b32 s18, 2048
  s_mov_b32 s19, 0x20000
  s_waitcnt lgkmcnt(0)
  s_barrier
  s_cmp_lg_u32 s3, 0
  s_cbranch_scc1 L_wdone
  v_lshlrev_b32 v27, 2, v1
  ds_read_b32 v104, v27 offset:4608
  ds_read_b32 v105, v27 offset:4736
  ds_read_b32 v106, v27 offset:4864
  ds_read_b32 v107, v27 offset:4992
  s_lshl_b32 s28, s35, 5
  v_lshlrev_b32 v22, 16, v22
  s_waitcnt lgkmcnt(0)
  v_add_f32 v104, v104, v105
  v_add_f32 v106, v106, v107
  v_add_f32 v104, v104, v22
  v_add_f32 v104, v104, v106
  v_cvt_pk_bf16_f32 v104, v104, v104
  s_mov_b32 exec_lo, -1
  s_mov_b32 exec_hi, 0
  buffer_store_short v104, v21, s[16:19], s28 offen
  s_cmp_lg_u32 s35, 0
  s_cbranch_scc1 L_wdone0
  s_mov_b64 exec, 1
  v_mov_b32 v30, s6
  v_mov_b32 v31, 0
  buffer_store_dword v30, v31, s[8:11], 0 offen offset:0
L_wdone0:
  s_mov_b64 exec, -1
L_wdone:
  s_endpgm
L_att:
  s_sub_u32 s38, s2, 128
  s_lshr_b32 s4, s38, 6
  s_lshl_b32 s30, s3, 5
  v_mov_b32 v32, v4
  v_mov_b32 v8, v32
  v_xor_b32 v9, 32, v32
  v_xor_b32 v10, 64, v32
  v_xor_b32 v11, 96, v32
  v_xor_b32 v12, 128, v32
  v_xor_b32 v13, 160, v32
  v_xor_b32 v14, 192, v32
  v_xor_b32 v15, 224, v32
  s_lshl_b32 s29, s38, 7
  s_add_u32 s29, s29, s30
  s_lshl_b32 s29, s29, 10
  s_lshl_b32 s31, s30, 10
  s_waitcnt lgkmcnt(0)
  s_mov_b32 s12, s66
  s_and_b32 s13, s67, 0xffff
  s_mov_b32 s14, 16777216
  s_mov_b32 s15, 0x20000
  s_load_dword s6, s[88:89], 0
  s_mov_b32 s8, s88
  s_and_b32 s9, s89, 0xffff
  s_mov_b32 s10, 268435456
  s_mov_b32 s11, 0x20000
  s_mov_b32 s30, s29
  s_add_u32 m0, s31, 32768
  s_nop 0
  buffer_load_dwordx4 v8, s[12:15], s30 offen lds
  s_waitcnt vmcnt(0)
  s_add_u32 s30, s29, 1024
  s_add_u32 m0, s31, 33792
  s_nop 0
  buffer_load_dwordx4 v9, s[12:15], s30 offen lds
  v_and_b32 v32, 3, v1
  v_bfe_u32 v33, v1, 3, 1
  v_lshl_add_u32 v32, v33, 2, v32
  v_lshlrev_b32 v32, 1, v32
  v_xor_b32 v33, v32, v3
  v_lshlrev_b32 v34, 10, v2
  s_lshl_b32 s37, s3, 15
  s_add_u32 s37, s37, 32768
  v_xor_b32 v35, 0, v33
  v_lshl_add_u32 v20, v35, 4, v34
  v_add_u32 v16, s37, v20
  v_xor_b32 v35, 4, v33
  v_lshl_add_u32 v21, v35, 4, v34
  v_add_u32 v17, s37, v21
  v_xor_b32 v35, 8, v33
  v_lshl_add_u32 v22, v35, 4, v34
  v_add_u32 v18, s37, v22
  v_xor_b32 v35, 12, v33
  v_lshl_add_u32 v23, v35, 4, v34
  v_add_u32 v19, s37, v23
  v_bfe_u32 v32, v1, 2, 2
  v_and_b32 v33, 3, v1
  v_and_b32 v34, 1, v3
  v_lshl_add_u32 v35, v34, 2, v32
  v_lshlrev_b32 v35, 1, v35
  v_lshl_add_u32 v36, v3, 3, v32
  v_lshlrev_b32 v36, 10, v36
  v_lshrrev_b32 v37, 1, v33
  v_lshl_add_u32 v36, v37, 4, v36
  v_and_b32 v37, 1, v33
  v_lshl_add_u32 v36, v37, 3, v36
  s_lshl_b32 s28, s3, 8
  s_add_u32 s28, s28, 32768
  v_add_u32 v36, s28, v36
  v_xor_b32 v37, 0, v35
  v_lshl_add_u32 v24, v37, 4, v36
  v_add_u32 v48, 65536, v24
  v_xor_b32 v37, 2, v35
  v_lshl_add_u32 v25, v37, 4, v36
  v_add_u32 v49, 65536, v25
  v_xor_b32 v37, 4, v35
  v_lshl_add_u32 v26, v37, 4, v36
  v_add_u32 v50, 65536, v26
  v_xor_b32 v37, 6, v35
  v_lshl_add_u32 v27, v37, 4, v36
  v_add_u32 v51, 65536, v27
  v_xor_b32 v37, 8, v35
  v_lshl_add_u32 v28, v37, 4, v36
  v_add_u32 v52, 65536, v28
  v_xor_b32 v37, 10, v35
  v_lshl_add_u32 v29, v37, 4, v36
  v_add_u32 v53, 65536, v29
  v_xor_b32 v37, 12, v35
  v_lshl_add_u32 v30, v37, 4, v36
  v_add_u32 v54, 65536, v30
  v_xor_b32 v37, 14, v35
  v_lshl_add_u32 v31, v37, 4, v36
  v_add_u32 v55, 65536, v31
  v_and_b32 v57, 31, v1
  v_lshlrev_b32 v57, 2, v57
  s_lshl_b32 s28, s3, 7
  v_add_u32 v56, s28, v57
  v_lshlrev_b32 v58, 2, v2
  v_lshrrev_b32 v32, 1, v3
  s_lshl_b32 s28, s3, 2
  v_add_u32 v32, s28, v32
  v_and_b32 v33, 1, v3
  v_lshlrev_b32 v33, 3, v33
  v_lshl_add_u32 v33, v2, 8, v33
  v_xor_b32 v34, v32, v2
  v_lshl_add_u32 v59, v34, 4, v33
  v_xor_b32 v63, 32, v59
  v_add_u32 v34, 0, v3
  v_xor_b32 v34, v34, v2
  v_lshlrev_b32 v34, 4, v34
  v_lshl_add_u32 v120, v2, 8, v34
  v_add_u32 v34, 4, v3
  v_xor_b32 v34, v34, v2
  v_lshlrev_b32 v34, 4, v34
  v_lshl_add_u32 v121, v2, 8, v34
  v_add_u32 v34, 8, v3
  v_xor_b32 v34, v34, v2
  v_lshlrev_b32 v34, 4, v34
  v_lshl_add_u32 v122, v2, 8, v34
  v_add_u32 v34, 12, v3
  v_xor_b32 v34, v34, v2
  v_lshlrev_b32 v34, 4, v34
  v_lshl_add_u32 v123, v2, 8, v34
  v_lshlrev_b32 v126, 4, v2
  v_lshl_add_u32 v124, v3, 10, v126
  v_lshlrev_b32 v125, 4, v1
  v_and_b32 v126, 31, v1
  v_lshlrev_b32 v126, 7, v126
  s_and_b32 s28, s3, 1
  s_lshl_b32 s28, s28, 7
  v_xor_b32 v127, s28, v4
  s_waitcnt vmcnt(0)
  s_add_u32 s30, s29, 2048
  s_add_u32 m0, s31, 34816
  s_nop 0
  buffer_load_dwordx4 v10, s[12:15], s30 offen lds
  s_waitcnt vmcnt(0)
  s_add_u32 s30, s29, 3072
  s_add_u32 m0, s31, 35840
  s_nop 0
  buffer_load_dwordx4 v11, s[12:15], s30 offen lds
  s_add_u32 s30, s29, 4096
  s_add_u32 m0, s31, 36864
  s_nop 0
  buffer_load_dwordx4 v8, s[12:15], s30 offen lds
  s_add_u32 s30, s29, 5120
  s_add_u32 m0, s31, 37888
  s_nop 0
  buffer_load_dwordx4 v9, s[12:15], s30 offen lds
  s_add_u32 s30, s29, 6144
  s_add_u32 m0, s31, 38912
  s_nop 0
  buffer_load_dwordx4 v10, s[12:15], s30 offen lds
  s_add_u32 s30, s29, 7168
  s_add_u32 m0, s31, 39936
  s_nop 0
  buffer_load_dwordx4 v11, s[12:15], s30 offen lds
  s_add_u32 s30, s29, 8192
  s_add_u32 m0, s31, 40960
  s_nop 0
  buffer_load_dwordx4 v12, s[12:15], s30 offen lds
  s_add_u32 s30, s29, 9216
  s_add_u32 m0, s31, 41984
  s_nop 0
  buffer_load_dwordx4 v13, s[12:15], s30 offen lds
  s_add_u32 s30, s29, 10240
  s_add_u32 m0, s31, 43008
  s_nop 0
  buffer_load_dwordx4 v14, s[12:15], s30 offen lds
  s_add_u32 s30, s29, 11264
  s_add_u32 m0, s31, 44032
  s_nop 0
  buffer_load_dwordx4 v15, s[12:15], s30 offen lds
  s_add_u32 s30, s29, 12288
  s_add_u32 m0, s31, 45056
  s_nop 0
  buffer_load_dwordx4 v12, s[12:15], s30 offen lds
  s_add_u32 s30, s29, 13312
  s_add_u32 m0, s31, 46080
  s_nop 0
  buffer_load_dwordx4 v13, s[12:15], s30 offen lds
  s_add_u32 s30, s29, 14336
  s_add_u32 m0, s31, 47104
  s_nop 0
  buffer_load_dwordx4 v14, s[12:15], s30 offen lds
  s_add_u32 s30, s29, 15360
  s_add_u32 m0, s31, 48128
  s_nop 0
  buffer_load_dwordx4 v15, s[12:15], s30 offen lds
  s_add_u32 s30, s29, 16384
  s_add_u32 m0, s31, 49152
  s_nop 0
  buffer_load_dwordx4 v8, s[12:15], s30 offen lds
  s_add_u32 s30, s29, 17408
  s_add_u32 m0, s31, 50176
  s_nop 0
  buffer_load_dwordx4 v9, s[12:15], s30 offen lds
  s_add_u32 s30, s29, 18432
  s_add_u32 m0, s31, 51200
  s_nop 0
  buffer_load_dwordx4 v10, s[12:15], s30 offen lds
  s_add_u32 s30, s29, 19456
  s_add_u32 m0, s31, 52224
  s_nop 0
  buffer_load_dwordx4 v11, s[12:15], s30 offen lds
  s_add_u32 s30, s29, 20480
  s_add_u32 m0, s31, 53248
  s_nop 0
  buffer_load_dwordx4 v8, s[12:15], s30 offen lds
  s_add_u32 s30, s29, 21504
  s_add_u32 m0, s31, 54272
  s_nop 0
  buffer_load_dwordx4 v9, s[12:15], s30 offen lds
  s_add_u32 s30, s29, 22528
  s_add_u32 m0, s31, 55296
  s_nop 0
  buffer_load_dwordx4 v10, s[12:15], s30 offen lds
  s_add_u32 s30, s29, 23552
  s_add_u32 m0, s31, 56320
  s_nop 0
  buffer_load_dwordx4 v11, s[12:15], s30 offen lds
  s_add_u32 s30, s29, 24576
  s_add_u32 m0, s31, 57344
  s_nop 0
  buffer_load_dwordx4 v12, s[12:15], s30 offen lds
  s_add_u32 s30, s29, 25600
  s_add_u32 m0, s31, 58368
  s_nop 0
  buffer_load_dwordx4 v13, s[12:15], s30 offen lds
  s_add_u32 s30, s29, 26624
  s_add_u32 m0, s31, 59392
  s_nop 0
  buffer_load_dwordx4 v14, s[12:15], s30 offen lds
  s_add_u32 s30, s29, 27648
  s_add_u32 m0, s31, 60416
  s_nop 0
  buffer_load_dwordx4 v15, s[12:15], s30 offen lds
  s_add_u32 s30, s29, 28672
  s_add_u32 m0, s31, 61440
  s_nop 0
  buffer_load_dwordx4 v12, s[12:15], s30 offen lds
  s_add_u32 s30, s29, 29696
  s_add_u32 m0, s31, 62464
  s_nop 0
  buffer_load_dwordx4 v13, s[12:15], s30 offen lds
  s_add_u32 s30, s29, 30720
  s_add_u32 m0, s31, 63488
  s_nop 0
  buffer_load_dwordx4 v14, s[12:15], s30 offen lds
  s_add_u32 s30, s29, 31744
  s_add_u32 m0, s31, 64512
  s_nop 0
  buffer_load_dwordx4 v15, s[12:15], s30 offen lds
L_streamdone_50:
  s_and_b32 s34, s63, 7
  s_lshl_b32 s34, s34, 11
  s_add_u32 s34, s34, 4096
  s_waitcnt lgkmcnt(0)
  s_add_u32 s6, s6, 0x9e3779b9
  s_lshl_b32 s29, s4, 15
  s_lshl_b32 s30, s3, 13
  s_add_u32 s29, s29, s30
  s_add_u32 s29, s29, 393216
  s_lshl_b32 s31, s3, 13
  s_cmp_lg_u32 s3, 0
  s_cbranch_scc1 L_nobp0_51
  buffer_load_dwordx2 v[236:237], v4, s[8:11], s34 offen sc1
  buffer_load_dwordx2 v[238:239], v4, s[8:11], s34 offen offset:1024 sc1
L_nobp0_51:
  s_waitcnt vmcnt(0)
  s_cmp_lg_u32 s3, 0
  s_cbranch_scc1 L_nobpoll_52
  v_xor_b32 v61, s6, v236
  v_xor_b32 v62, s6, v237
  v_or_b32 v60, v61, v62
  v_xor_b32 v61, s6, v238
  v_xor_b32 v62, s6, v239
  v_or3_b32 v60, v60, v61, v62
  v_cmp_ne_u32 vcc, 0, v60
  s_cbranch_vccz L_nobpoll_52
  s_mov_b32 s48, 200000
  buffer_load_dwordx2 v[240:241], v4, s[8:11], s34 offen sc1
  buffer_load_dwordx2 v[242:243], v4, s[8:11], s34 offen offset:1024 sc1
  s_sleep 4
  buffer_load_dwordx2 v[244:245], v4, s[8:11], s34 offen sc1
  buffer_load_dwordx2 v[246:247], v4, s[8:11], s34 offen offset:1024 sc1
  s_sleep 4
L_poll_53:
  buffer_load_dwordx2 v[248:249], v4, s[8:11], s34 offen sc1
  buffer_load_dwordx2 v[250:251], v4, s[8:11], s34 offen offset:1024 sc1
  s_waitcnt vmcnt(4)
  v_xor_b32 v61, s6, v240
  v_xor_b32 v62, s6, v241
  v_or_b32 v60, v61, v62
  v_xor_b32 v61, s6, v242
  v_xor_b32 v62, s6, v243
  v_or3_b32 v60, v60, v61, v62
  v_cmp_ne_u32 vcc, 0, v60
  s_cbranch_vccz L_pexit_55
  s_sleep 4
  buffer_load_dwordx2 v[240:241], v4, s[8:11], s34 offen sc1
  buffer_load_dwordx2 v[242:243], v4, s[8:11], s34 offen offset:1024 sc1
  s_waitcnt vmcnt(4)
  v_xor_b32 v61, s6, v244
  v_xor_b32 v62, s6, v245
  v_or_b32 v60, v61, v62
  v_xor_b32 v61, s6, v246
  v_xor_b32 v62, s6, v247
  v_or3_b32 v60, v60, v61, v62
  v_cmp_ne_u32 vcc, 0, v60
  s_cbranch_vccz L_pexit_56
  s_sleep 4
  buffer_load_dwordx2 v[244:245], v4, s[8:11], s34 offen sc1
  buffer_load_dwordx2 v[246:247], v4, s[8:11], s34 offen offset:1024 sc1
  s_waitcnt vmcnt(4)
  v_xor_b32 v61, s6, v248
  v_xor_b32 v62, s6, v249
  v_or_b32 v60, v61, v62
  v_xor_b32 v61, s6, v250
  v_xor_b32 v62, s6, v251
  v_or3_b32 v60, v60, v61, v62
  v_cmp_ne_u32 vcc, 0, v60
  s_cbranch_vccz L_pexit_57
  s_sleep 4
  s_sub_u32 s48, s48, 1
  s_cbranch_scc0 L_poll_53
L_pexit_55:
  v_mov_b32 v40, v240
  v_mov_b32 v41, v241
  v_mov_b32 v42, v242
  v_mov_b32 v43, v243
  s_branch L_pdone_54
L_pexit_56:
  v_mov_b32 v40, v244
  v_mov_b32 v41, v245
  v_mov_b32 v42, v246
  v_mov_b32 v43, v247
  s_branch L_pdone_54
L_pexit_57:
  v_mov_b32 v40, v248
  v_mov_b32 v41, v249
  v_mov_b32 v42, v250
  v_mov_b32 v43, v251
L_pdone_54:
L_nobpoll_52:
  s_barrier
  v_mov_b32 v44, v127
  s_mov_b32 s30, s29
  s_add_u32 m0, s31, 0
  s_nop 0
  buffer_load_dwordx4 v44, s[8:11], s30 offen sc1 lds
  v_xor_b32 v44, 32, v127
  s_add_u32 s30, s29, 1024
  s_add_u32 m0, s31, 1024
  s_nop 0
  buffer_load_dwordx4 v44, s[8:11], s30 offen sc1 lds
  v_xor_b32 v44, 64, v127
  s_add_u32 s30, s29, 2048
  s_add_u32 m0, s31, 2048
  s_nop 0
  buffer_load_dwordx4 v44, s[8:11], s30 offen sc1 lds
  v_xor_b32 v44, 96, v127
  s_add_u32 s30, s29, 3072
  s_add_u32 m0, s31, 3072
  s_nop 0
  buffer_load_dwordx4 v44, s[8:11], s30 offen sc1 lds
  v_mov_b32 v44, v127
  s_add_u32 s30, s29, 4096
  s_add_u32 m0, s31, 4096
  s_nop 0
  buffer_load_dwordx4 v44, s[8:11], s30 offen sc1 lds
  v_xor_b32 v44, 32, v127
  s_add_u32 s30, s29, 5120
  s_add_u32 m0, s31, 5120
  s_nop 0
  buffer_load_dwordx4 v44, s[8:11], s30 offen sc1 lds
  v_xor_b32 v44, 64, v127
  s_add_u32 s30, s29, 6144
  s_add_u32 m0, s31, 6144
  s_nop 0
  buffer_load_dwordx4 v44, s[8:11], s30 offen sc1 lds
  v_xor_b32 v44, 96, v127
  s_add_u32 s30, s29, 7168
  s_add_u32 m0, s31, 7168
  s_nop 0
  buffer_load_dwordx4 v44, s[8:11], s30 offen sc1 lds
  ds_read_b128 a[0:3], v16 offset:0
  ds_read_b128 a[64:67], v16 offset:16384
  ds_read_b128 a[4:7], v17 offset:0
  ds_read_b128 a[68:71], v17 offset:16384
  ds_read_b128 a[8:11], v18 offset:0
  ds_read_b128 a[72:75], v18 offset:16384
  ds_read_b128 a[12:15], v19 offset:0
  ds_read_b128 a[76:79], v19 offset:16384
  ds_read_b128 a[16:19], v16 offset:256
  ds_read_b128 a[80:83], v16 offset:16640
  ds_read_b128 a[20:23], v17 offset:256
  ds_read_b128 a[84:87], v17 offset:16640
  ds_read_b128 a[24:27], v18 offset:256
  ds_read_b128 a[88:91], v18 offset:16640
  ds_read_b128 a[28:31], v19 offset:256
  ds_read_b128 a[92:95], v19 offset:16640
  ds_read_b128 a[32:35], v16 offset:512
  ds_read_b128 a[96:99], v16 offset:16896
  ds_read_b128 a[36:39], v17 offset:512
  ds_read_b128 a[100:103], v17 offset:16896
  ds_read_b128 a[40:43], v18 offset:512
  ds_read_b128 a[104:107], v18 offset:16896
  ds_read_b128 a[44:47], v19 offset:512
  ds_read_b128 a[108:111], v19 offset:16896
  ds_read_b128 a[48:51], v16 offset:768
  ds_read_b128 a[112:115], v16 offset:17152
  ds_read_b128 a[52:55], v17 offset:768
  ds_read_b128 a[116:119], v17 offset:17152
  ds_read_b128 a[56:59], v18 offset:768
  ds_read_b128 a[120:123], v18 offset:17152
  ds_read_b128 a[60:63], v19 offset:768
  ds_read_b128 a[124:127], v19 offset:17152
  ds_read_b64_tr_b16 a[128:129], v24 offset:0
  ds_read_b64_tr_b16 a[130:131], v24 offset:4096
  ds_read_b64_tr_b16 a[132:133], v25 offset:0
  ds_read_b64_tr_b16 a[134:135], v25 offset:4096
  ds_read_b64_tr_b16 a[136:137], v26 offset:0
  ds_read_b64_tr_b16 a[138:139], v26 offset:4096
  ds_read_b64_tr_b16 a[140:141], v27 offset:0
  ds_read_b64_tr_b16 a[142:143], v27 offset:4096
  ds_read_b64_tr_b16 a[144:145], v28 offset:0
  ds_read_b64_tr_b16 a[146:147], v28 offset:4096
  ds_read_b64_tr_b16 a[148:149], v29 offset:0
  ds_read_b64_tr_b16 a[150:151], v29 offset:4096
  ds_read_b64_tr_b16 a[152:153], v30 offset:0
  ds_read_b64_tr_b16 a[154:155], v30 offset:4096
  ds_read_b64_tr_b16 a[156:157], v31 offset:0
  ds_read_b64_tr_b16 a[158:159], v31 offset:4096
  ds_read_b64_tr_b16 a[160:161], v24 offset:32768
  ds_read_b64_tr_b16 a[162:163], v24 offset:36864
  ds_read_b64_tr_b16 a[164:165], v25 offset:32768
  ds_read_b64_tr_b16 a[166:167], v25 offset:36864
  ds_read_b64_tr_b16 a[168:169], v26 offset:32768
  ds_read_b64_tr_b16 a[170:171], v26 offset:36864
  ds_read_b64_tr_b16 a[172:173], v27 offset:32768
  ds_read_b64_tr_b16 a[174:175], v27 offset:36864
  ds_read_b64_tr_b16 a[176:177], v28 offset:32768
  ds_read_b64_tr_b16 a[178:179], v28 offset:36864
  ds_read_b64_tr_b16 a[180:181], v29 offset:32768
  ds_read_b64_tr_b16 a[182:183], v29 offset:36864
  ds_read_b64_tr_b16 a[184:185], v30 offset:32768
  ds_read_b64_tr_b16 a[186:187], v30 offset:36864
  ds_read_b64_tr_b16 a[188:189], v31 offset:32768
  ds_read_b64_tr_b16 a[190:191], v31 offset:36864
  ds_read_b64_tr_b16 a[192:193], v48 offset:0
  ds_read_b64_tr_b16 a[194:195], v48 offset:4096
  ds_read_b64_tr_b16 a[196:197], v49 offset:0
  ds_read_b64_tr_b16 a[198:199], v49 offset:4096
  ds_read_b64_tr_b16 a[200:201], v50 offset:0
  ds_read_b64_tr_b16 a[202:203], v50 offset:4096
  ds_read_b64_tr_b16 a[204:205], v51 offset:0
  ds_read_b64_tr_b16 a[206:207], v51 offset:4096
  ds_read_b64_tr_b16 a[208:209], v52 offset:0
  ds_read_b64_tr_b16 a[210:211], v52 offset:4096
  ds_read_b64_tr_b16 a[212:213], v53 offset:0
  ds_read_b64_tr_b16 a[214:215], v53 offset:4096
  ds_read_b64_tr_b16 a[216:217], v54 offset:0
  ds_read_b64_tr_b16 a[218:219], v54 offset:4096
  ds_read_b64_tr_b16 a[220:221], v55 offset:0
  ds_read_b64_tr_b16 a[222:223], v55 offset:4096
  ds_read_b64_tr_b16 a[224:225], v48 offset:32768
  ds_read_b64_tr_b16 a[226:227], v48 offset:36864
  ds_read_b64_tr_b16 a[228:229], v49 offset:32768
  ds_read_b64_tr_b16 a[230:231], v49 offset:36864
  ds_read_b64_tr_b16 a[232:233], v50 offset:32768
  ds_read_b64_tr_b16 a[234:235], v50 offset:36864
  ds_read_b64_tr_b16 a[236:237], v51 offset:32768
  ds_read_b64_tr_b16 a[238:239], v51 offset:36864
  ds_read_b64_tr_b16 a[240:241], v52 offset:32768
  ds_read_b64_tr_b16 a[242:243], v52 offset:36864
  ds_read_b64_tr_b16 a[244:245], v53 offset:32768
  ds_read_b64_tr_b16 a[246:247], v53 offset:36864
  ds_read_b64_tr_b16 a[248:249], v54 offset:32768
  ds_read_b64_tr_b16 a[250:251], v54 offset:36864
  ds_read_b64_tr_b16 a[252:253], v55 offset:32768
  ds_read_b64_tr_b16 a[254:255], v55 offset:36864
  s_lshl_b32 s28, s38, 2
  s_add_u32 s28, s28, s3
  s_lshl_b32 s28, s28, 13
  s_add_u32 s34, s28, 2097152
  s_add_u32 s35, s34, 4096
  s_lshl_b32 s28, s3, 7
  s_add_u32 s28, s28, s38
  s_lshl_b32 s28, s28, 9
  s_add_u32 s36, s28, 1376256
  s_lshl_b32 s28, s3, 7
  s_add_u32 s28, s28, s38
  s_lshl_b32 s28, s28, 4
  s_add_u32 s37, s28, 1900544
  v_lshlrev_b32 v126, 13, v1
  v_mov_b32 v252, s6
  v_mov_b32 v253, s6
  s_waitcnt vmcnt(0) lgkmcnt(0)
  s_barrier
  ds_read_b128 v[64:67], v20 offset:0
  ds_read_b128 v[68:71], v20 offset:16384
  ds_read_b128 v[72:75], v21 offset:0
  ds_read_b128 v[76:79], v21 offset:16384
  ds_read_b128 v[80:83], v22 offset:0
  ds_read_b128 v[84:87], v22 offset:16384
  s_waitcnt lgkmcnt(4)
  v_mfma_f32_16x16x32_bf16 v[192:195], a[0:3], v[64:67], 0
  v_mfma_f32_16x16x32_bf16 v[196:199], a[0:3], v[68:71], 0
  v_mfma_f32_16x16x32_bf16 v[200:203], a[64:67], v[64:67], 0
  v_mfma_f32_16x16x32_bf16 v[204:207], a[64:67], v[68:71], 0
  ds_read_b128 v[64:67], v23 offset:0
  ds_read_b128 v[68:71], v23 offset:16384
  s_waitcnt lgkmcnt(4)
  v_mfma_f32_16x16x32_bf16 v[192:195], a[4:7], v[72:75], v[192:195]
  v_mfma_f32_16x16x32_bf16 v[196:199], a[4:7], v[76:79], v[196:199]
  v_mfma_f32_16x16x32_bf16 v[200:203], a[68:71], v[72:75], v[200:203]
  v_mfma_f32_16x16x32_bf16 v[204:207], a[68:71], v[76:79], v[204:207]
  ds_read_b128 v[72:75], v20 offset:256
  ds_read_b128 v[76:79], v20 offset:16640
  s_waitcnt lgkmcnt(4)
  v_mfma_f32_16x16x32_bf16 v[192:195], a[8:11], v[80:83], v[192:195]
  v_mfma_f32_16x16x32_bf16 v[196:199], a[8:11], v[84:87], v[196:199]
  v_mfma_f32_16x16x32_bf16 v[200:203], a[72:75], v[80:83], v[200:203]
  v_mfma_f32_16x16x32_bf16 v[204:207], a[72:75], v[84:87], v[204:207]
  ds_read_b128 v[80:83], v21 offset:256
  ds_read_b128 v[84:87], v21 offset:16640
  s_waitcnt lgkmcnt(4)
  v_mfma_f32_16x16x32_bf16 v[192:195], a[12:15], v[64:67], v[192:195]
  v_mfma_f32_16x16x32_bf16 v[196:199], a[12:15], v[68:71], v[196:199]
  v_mfma_f32_16x16x32_bf16 v[200:203], a[76:79], v[64:67], v[200:203]
  v_mfma_f32_16x16x32_bf16 v[204:207], a[76:79], v[68:71], v[204:207]
  ds_read_b128 v[64:67], v22 offset:256
  ds_read_b128 v[68:71], v22 offset:16640
  s_waitcnt lgkmcnt(4)
  v_mfma_f32_16x16x32_bf16 v[192:195], a[16:19], v[72:75], v[192:195]
  v_mfma_f32_16x16x32_bf16 v[196:199], a[16:19], v[76:79], v[196:199]
  v_mfma_f32_16x16x32_bf16 v[200:203], a[80:83], v[72:75], v[200:203]
  v_mfma_f32_16x16x32_bf16 v[204:207], a[80:83], v[76:79], v[204:207]
  ds_read_b128 v[72:75], v23 offset:256
  ds_read_b128 v[76:79], v23 offset:16640
  s_waitcnt lgkmcnt(4)
  v_mfma_f32_16x16x32_bf16 v[192:195], a[20:23], v[80:83], v[192:195]
  v_mfma_f32_16x16x32_bf16 v[196:199], a[20:23], v[84:87], v[196:199]
  v_mfma_f32_16x16x32_bf16 v[200:203], a[84:87], v[80:83], v[200:203]
  v_mfma_f32_16x16x32_bf16 v[204:207], a[84:87], v[84:87], v[204:207]
  ds_read_b128 v[80:83], v20 offset:512
  ds_read_b128 v[84:87], v20 offset:16896
  s_waitcnt lgkmcnt(4)
  v_mfma_f32_16x16x32_bf16 v[192:195], a[24:27], v[64:67], v[192:195]
  v_mfma_f32_16x16x32_bf16 v[196:199], a[24:27], v[68:71], v[196:199]
  v_mfma_f32_16x16x32_bf16 v[200:203], a[88:91], v[64:67], v[200:203]
  v_mfma_f32_16x16x32_bf16 v[204:207], a[88:91], v[68:71], v[204:207]
  ds_read_b128 v[64:67], v21 offset:512
  ds_read_b128 v[68:71], v21 offset:16896
  s_waitcnt lgkmcnt(4)
  v_mfma_f32_16x16x32_bf16 v[192:195], a[28:31], v[72:75], v[192:195]
  v_mfma_f32_16x16x32_bf16 v[196:199], a[28:31], v[76:79], v[196:199]
  v_mfma_f32_16x16x32_bf16 v[200:203], a[92:95], v[72:75], v[200:203]
  v_mfma_f32_16x16x32_bf16 v[204:207], a[92:95], v[76:79], v[204:207]
  ds_read_b128 v[72:75], v22 offset:512
  ds_read_b128 v[76:79], v22 offset:16896
  s_waitcnt lgkmcnt(4)
  v_mfma_f32_16x16x32_bf16 v[192:195], a[32:35], v[80:83], v[192:195]
  v_mfma_f32_16x16x32_bf16 v[196:199], a[32:35], v[84:87], v[196:199]
  v_mfma_f32_16x16x32_bf16 v[200:203], a[96:99], v[80:83], v[200:203]
  v_mfma_f32_16x16x32_bf16 v[204:207], a[96:99], v[84:87], v[204:207]
  ds_read_b128 v[80:83], v23 offset:512
  ds_read_b128 v[84:87], v23 offset:16896
  s_waitcnt lgkmcnt(4)
  v_mfma_f32_16x16x32_bf16 v[192:195], a[36:39], v[64:67], v[192:195]
  v_mfma_f32_16x16x32_bf16 v[196:199], a[36:39], v[68:71], v[196:199]
  v_mfma_f32_16x16x32_bf16 v[200:203], a[100:103], v[64:67], v[200:203]
  v_mfma_f32_16x16x32_bf16 v[204:207], a[100:103], v[68:71], v[204:207]
  ds_read_b128 v[64:67], v20 offset:768
  ds_read_b128 v[68:71], v20 offset:17152
  s_waitcnt lgkmcnt(4)
  v_mfma_f32_16x16x32_bf16 v[192:195], a[40:43], v[72:75], v[192:195]
  v_mfma_f32_16x16x32_bf16 v[196:199], a[40:43], v[76:79], v[196:199]
  v_mfma_f32_16x16x32_bf16 v[200:203], a[104:107], v[72:75], v[200:203]
  v_mfma_f32_16x16x32_bf16 v[204:207], a[104:107], v[76:79], v[204:207]
  ds_read_b128 v[72:75], v21 offset:768
  ds_read_b128 v[76:79], v21 offset:17152
  s_waitcnt lgkmcnt(4)
  v_mfma_f32_16x16x32_bf16 v[192:195], a[44:47], v[80:83], v[192:195]
  v_mfma_f32_16x16x32_bf16 v[196:199], a[44:47], v[84:87], v[196:199]
  v_mfma_f32_16x16x32_bf16 v[200:203], a[108:111], v[80:83], v[200:203]
  v_mfma_f32_16x16x32_bf16 v[204:207], a[108:111], v[84:87], v[204:207]
  ds_read_b128 v[80:83], v22 offset:768
  ds_read_b128 v[84:87], v22 offset:17152
  s_waitcnt lgkmcnt(4)
  v_mfma_f32_16x16x32_bf16 v[192:195], a[48:51], v[64:67], v[192:195]
  v_mfma_f32_16x16x32_bf16 v[196:199], a[48:51], v[68:71], v[196:199]
  v_mfma_f32_16x16x32_bf16 v[200:203], a[112:115], v[64:67], v[200:203]
  v_mfma_f32_16x16x32_bf16 v[204:207], a[112:115], v[68:71], v[204:207]
  ds_read_b128 v[64:67], v23 offset:768
  ds_read_b128 v[68:71], v23 offset:17152
  s_waitcnt lgkmcnt(4)
  v_mfma_f32_16x16x32_bf16 v[192:195], a[52:55], v[72:75], v[192:195]
  v_mfma_f32_16x16x32_bf16 v[196:199], a[52:55], v[76:79], v[196:199]
  v_mfma_f32_16x16x32_bf16 v[200:203], a[116:119], v[72:75], v[200:203]
  v_mfma_f32_16x16x32_bf16 v[204:207], a[116:119], v[76:79], v[204:207]
  s_waitcnt lgkmcnt(2)
  v_mfma_f32_16x16x32_bf16 v[192:195], a[56:59], v[80:83], v[192:195]
  v_mfma_f32_16x16x32_bf16 v[196:199], a[56:59], v[84:87], v[196:199]
  v_mfma_f32_16x16x32_bf16 v[200:203], a[120:123], v[80:83], v[200:203]
  v_mfma_f32_16x16x32_bf16 v[204:207], a[120:123], v[84:87], v[204:207]
  s_waitcnt lgkmcnt(0)
  v_mfma_f32_16x16x32_bf16 v[192:195], a[60:63], v[64:67], v[192:195]
  v_mfma_f32_16x16x32_bf16 v[196:199], a[60:63], v[68:71], v[196:199]
  v_mfma_f32_16x16x32_bf16 v[200:203], a[124:127], v[64:67], v[200:203]
  v_mfma_f32_16x16x32_bf16 v[204:207], a[124:127], v[68:71], v[204:207]
  s_nop 8
  v_max3_f32 v32, v192, v193, v194
  v_max3_f32 v33, v196, v197, v198
  v_max3_f32 v32, v32, v195, v200
  v_max3_f32 v33, v33, v199, v204
  v_max3_f32 v32, v32, v201, v202
  v_max3_f32 v33, v33, v205, v206
  v_max_f32 v32, v32, v203
  v_max_f32 v33, v33, v207
  v_mov_b32 v34, v32
  v_mov_b32 v35, v33
  s_nop 0
  v_permlane16_swap_b32 v32, v34
  v_permlane16_swap_b32 v33, v35
  s_nop 0
  v_max_f32 v32, v32, v34
  v_max_f32 v33, v33, v35
  v_mov_b32 v34, v32
  v_mov_b32 v35, v33
  s_nop 0
  v_permlane32_swap_b32 v32, v34
  v_permlane32_swap_b32 v33, v35
  s_nop 0
  v_max_f32 v32, v32, v34
  v_max_f32 v33, v33, v35
  v_cndmask_b32 v36, v32, v33, s[44:45]
  ds_write_b32 v56, v36 offset:32768
  s_waitcnt lgkmcnt(0)
  s_barrier
  ds_read_b32 v40, v58 offset:32768
  ds_read_b32 v41, v58 offset:32896
  ds_read_b32 v42, v58 offset:33024
  ds_read_b32 v43, v58 offset:33152
  ds_read_b32 v44, v58 offset:32832
  ds_read_b32 v45, v58 offset:32960
  ds_read_b32 v46, v58 offset:33088
  ds_read_b32 v47, v58 offset:33216
  s_waitcnt lgkmcnt(0)
  v_max3_f32 v32, v40, v41, v42
  v_max3_f32 v33, v44, v45, v46
  v_max_f32 v32, v32, v43
  v_max_f32 v33, v33, v47
  v_sub_f32 v192, v192, v32
  v_sub_f32 v193, v193, v32
  v_sub_f32 v194, v194, v32
  v_sub_f32 v195, v195, v32
  v_sub_f32 v196, v196, v33
  v_sub_f32 v197, v197, v33
  v_sub_f32 v198, v198, v33
  v_sub_f32 v199, v199, v33
  v_sub_f32 v200, v200, v32
  v_sub_f32 v201, v201, v32
  v_sub_f32 v202, v202, v32
  v_sub_f32 v203, v203, v32
  v_sub_f32 v204, v204, v33
  v_sub_f32 v205, v205, v33
  v_sub_f32 v206, v206, v33
  v_sub_f32 v207, v207, v33
  v_exp_f32 v192, v192
  v_exp_f32 v193, v193
  v_exp_f32 v194, v194
  v_exp_f32 v195, v195
  v_exp_f32 v196, v196
  v_exp_f32 v197, v197
  v_exp_f32 v198, v198
  v_exp_f32 v199, v199
  v_exp_f32 v200, v200
  v_exp_f32 v201, v201
  v_exp_f32 v202, v202
  v_exp_f32 v203, v203
  v_exp_f32 v204, v204
  v_exp_f32 v205, v205
  v_exp_f32 v206, v206
  v_exp_f32 v207, v207
  v_cvt_pk_bf16_f32 v88, v192, v193
  v_cvt_pk_bf16_f32 v89, v194, v195
  ds_write_b64 v59, v[88:89] offset:36864
  v_cvt_pk_bf16_f32 v90, v196, v197
  v_cvt_pk_bf16_f32 v91, v198, v199
  ds_write_b64 v59, v[90:91] offset:40960
  v_cvt_pk_bf16_f32 v92, v200, v201
  v_cvt_pk_bf16_f32 v93, v202, v203
  ds_write_b64 v63, v[92:93] offset:36864
  v_cvt_pk_bf16_f32 v94, v204, v205
  v_cvt_pk_bf16_f32 v95, v206, v207
  ds_write_b64 v63, v[94:95] offset:40960
  v_add_f32 v34, v192, v193
  v_add_f32 v35, v196, v197
  v_add_f32 v34, v34, v194
  v_add_f32 v35, v35, v198
  v_add_f32 v34, v34, v195
  v_add_f32 v35, v35, v199
  v_add_f32 v34, v34, v200
  v_add_f32 v35, v35, v204
  v_add_f32 v34, v34, v201
  v_add_f32 v35, v35, v205
  v_add_f32 v34, v34, v202
  v_add_f32 v35, v35, v206
  v_add_f32 v34, v34, v203
  v_add_f32 v35, v35, v207
  v_mov_b32 v46, v34
  v_mov_b32 v47, v35
  s_nop 0
  v_permlane16_swap_b32 v34, v46
  v_permlane16_swap_b32 v35, v47
  s_nop 0
  v_add_f32 v34, v34, v46
  v_add_f32 v35, v35, v47
  v_mov_b32 v46, v34
  v_mov_b32 v47, v35
  s_nop 0
  v_permlane32_swap_b32 v34, v46
  v_permlane32_swap_b32 v35, v47
  s_nop 0
  v_add_f32 v34, v34, v46
  v_add_f32 v35, v35, v47
  v_cndmask_b32 v36, v34, v35, s[44:45]
  ds_write_b32 v56, v36 offset:33280
  s_waitcnt lgkmcnt(0)
  s_barrier
  ds_read_b128 v[208:211], v120 offset:36864
  ds_read_b128 v[212:215], v121 offset:36864
  ds_read_b128 v[216:219], v122 offset:36864
  ds_read_b128 v[220:223], v123 offset:36864
  ds_read_b128 v[224:227], v120 offset:40960
  ds_read_b128 v[228:231], v121 offset:40960
  ds_read_b128 v[232:235], v122 offset:40960
  ds_read_b128 v[236:239], v123 offset:40960
  ds_read_b32 v240, v57 offset:33280
  ds_read_b32 v241, v57 offset:33408
  ds_read_b32 v242, v57 offset:33536
  ds_read_b32 v243, v57 offset:33664
  s_waitcnt lgkmcnt(11)
  v_mfma_f32_16x16x32_bf16 v[128:131], v[208:211], a[128:131], 0
  v_mfma_f32_16x16x32_bf16 v[132:135], v[208:211], a[132:135], 0
  v_mfma_f32_16x16x32_bf16 v[136:139], v[208:211], a[136:139], 0
  v_mfma_f32_16x16x32_bf16 v[140:143], v[208:211], a[140:143], 0
  v_mfma_f32_16x16x32_bf16 v[144:147], v[208:211], a[144:147], 0
  v_mfma_f32_16x16x32_bf16 v[148:151], v[208:211], a[148:151], 0
  v_mfma_f32_16x16x32_bf16 v[152:155], v[208:211], a[152:155], 0
  v_mfma_f32_16x16x32_bf16 v[156:159], v[208:211], a[156:159], 0
  s_waitcnt lgkmcnt(10)
  v_mfma_f32_16x16x32_bf16 v[128:131], v[212:215], a[160:163], v[128:131]
  v_mfma_f32_16x16x32_bf16 v[132:135], v[212:215], a[164:167], v[132:135]
  v_mfma_f32_16x16x32_bf16 v[136:139], v[212:215], a[168:171], v[136:139]
  v_mfma_f32_16x16x32_bf16 v[140:143], v[212:215], a[172:175], v[140:143]
  v_mfma_f32_16x16x32_bf16 v[144:147], v[212:215], a[176:179], v[144:147]
  v_mfma_f32_16x16x32_bf16 v[148:151], v[212:215], a[180:183], v[148:151]
  v_mfma_f32_16x16x32_bf16 v[152:155], v[212:215], a[184:187], v[152:155]
  v_mfma_f32_16x16x32_bf16 v[156:159], v[212:215], a[188:191], v[156:159]
  s_waitcnt lgkmcnt(9)
  v_mfma_f32_16x16x32_bf16 v[128:131], v[216:219], a[192:195], v[128:131]
  v_mfma_f32_16x16x32_bf16 v[132:135], v[216:219], a[196:199], v[132:135]
  v_mfma_f32_16x16x32_bf16 v[136:139], v[216:219], a[200:203], v[136:139]
  v_mfma_f32_16x16x32_bf16 v[140:143], v[216:219], a[204:207], v[140:143]
  v_mfma_f32_16x16x32_bf16 v[144:147], v[216:219], a[208:211], v[144:147]
  v_mfma_f32_16x16x32_bf16 v[148:151], v[216:219], a[212:215], v[148:151]
  v_mfma_f32_16x16x32_bf16 v[152:155], v[216:219], a[216:219], v[152:155]
  v_mfma_f32_16x16x32_bf16 v[156:159], v[216:219], a[220:223], v[156:159]
  s_waitcnt lgkmcnt(8)
  v_mfma_f32_16x16x32_bf16 v[128:131], v[220:223], a[224:227], v[128:131]
  v_mfma_f32_16x16x32_bf16 v[132:135], v[220:223], a[228:231], v[132:135]
  v_mfma_f32_16x16x32_bf16 v[136:139], v[220:223], a[232:235], v[136:139]
  v_mfma_f32_16x16x32_bf16 v[140:143], v[220:223], a[236:239], v[140:143]
  v_mfma_f32_16x16x32_bf16 v[144:147], v[220:223], a[240:243], v[144:147]
  v_mfma_f32_16x16x32_bf16 v[148:151], v[220:223], a[244:247], v[148:151]
  v_mfma_f32_16x16x32_bf16 v[152:155], v[220:223], a[248:251], v[152:155]
  v_mfma_f32_16x16x32_bf16 v[156:159], v[220:223], a[252:255], v[156:159]
  s_waitcnt lgkmcnt(0)
  v_mfma_f32_16x16x32_bf16 v[160:163], v[224:227], a[128:131], 0
  v_mfma_f32_16x16x32_bf16 v[164:167], v[224:227], a[132:135], 0
  v_mfma_f32_16x16x32_bf16 v[168:171], v[224:227], a[136:139], 0
  v_mfma_f32_16x16x32_bf16 v[172:175], v[224:227], a[140:143], 0
  v_mfma_f32_16x16x32_bf16 v[176:179], v[224:227], a[144:147], 0
  v_mfma_f32_16x16x32_bf16 v[180:183], v[224:227], a[148:151], 0
  v_mfma_f32_16x16x32_bf16 v[184:187], v[224:227], a[152:155], 0
  v_mfma_f32_16x16x32_bf16 v[188:191], v[224:227], a[156:159], 0
  v_mfma_f32_16x16x32_bf16 v[160:163], v[228:231], a[160:163], v[160:163]
  v_cvt_pk_bf16_f32 v88, v128, v132
  v_mfma_f32_16x16x32_bf16 v[164:167], v[228:231], a[164:167], v[164:167]
  v_cvt_pk_bf16_f32 v92, v129, v133
  v_mfma_f32_16x16x32_bf16 v[168:171], v[228:231], a[168:171], v[168:171]
  v_cvt_pk_bf16_f32 v96, v130, v134
  v_mfma_f32_16x16x32_bf16 v[172:175], v[228:231], a[172:175], v[172:175]
  v_cvt_pk_bf16_f32 v100, v131, v135
  v_mfma_f32_16x16x32_bf16 v[176:179], v[228:231], a[176:179], v[176:179]
  v_cvt_pk_bf16_f32 v89, v136, v140
  v_mfma_f32_16x16x32_bf16 v[180:183], v[228:231], a[180:183], v[180:183]
  v_cvt_pk_bf16_f32 v93, v137, v141
  v_mfma_f32_16x16x32_bf16 v[184:187], v[228:231], a[184:187], v[184:187]
  v_cvt_pk_bf16_f32 v97, v138, v142
  v_mfma_f32_16x16x32_bf16 v[188:191], v[228:231], a[188:191], v[188:191]
  v_cvt_pk_bf16_f32 v101, v139, v143
  v_mfma_f32_16x16x32_bf16 v[160:163], v[232:235], a[192:195], v[160:163]
  v_cvt_pk_bf16_f32 v90, v144, v148
  v_mfma_f32_16x16x32_bf16 v[164:167], v[232:235], a[196:199], v[164:167]
  v_cvt_pk_bf16_f32 v94, v145, v149
  v_mfma_f32_16x16x32_bf16 v[168:171], v[232:235], a[200:203], v[168:171]
  v_cvt_pk_bf16_f32 v98, v146, v150
  v_mfma_f32_16x16x32_bf16 v[172:175], v[232:235], a[204:207], v[172:175]
  v_cvt_pk_bf16_f32 v102, v147, v151
  v_mfma_f32_16x16x32_bf16 v[176:179], v[232:235], a[208:211], v[176:179]
  v_cvt_pk_bf16_f32 v91, v152, v156
  v_mfma_f32_16x16x32_bf16 v[180:183], v[232:235], a[212:215], v[180:183]
  v_cvt_pk_bf16_f32 v95, v153, v157
  v_mfma_f32_16x16x32_bf16 v[184:187], v[232:235], a[216:219], v[184:187]
  v_cvt_pk_bf16_f32 v99, v154, v158
  v_mfma_f32_16x16x32_bf16 v[188:191], v[232:235], a[220:223], v[188:191]
  v_cvt_pk_bf16_f32 v103, v155, v159
  v_mfma_f32_16x16x32_bf16 v[160:163], v[236:239], a[224:227], v[160:163]
  buffer_store_dwordx4 v[88:91], v124, s[8:11], s34 offen offset:0 sc1
  buffer_store_dwordx4 v[92:95], v124, s[8:11], s34 offen offset:256 sc1
  buffer_store_dwordx4 v[96:99], v124, s[8:11], s34 offen offset:512 sc1
  buffer_store_dwordx4 v[100:103], v124, s[8:11], s34 offen offset:768 sc1
  v_mfma_f32_16x16x32_bf16 v[164:167], v[236:239], a[228:231], v[164:167]
  v_mfma_f32_16x16x32_bf16 v[168:171], v[236:239], a[232:235], v[168:171]
  v_mfma_f32_16x16x32_bf16 v[172:175], v[236:239], a[236:239], v[172:175]
  v_mfma_f32_16x16x32_bf16 v[176:179], v[236:239], a[240:243], v[176:179]
  v_mfma_f32_16x16x32_bf16 v[180:183], v[236:239], a[244:247], v[180:183]
  v_mfma_f32_16x16x32_bf16 v[184:187], v[236:239], a[248:251], v[184:187]
  v_mfma_f32_16x16x32_bf16 v[188:191], v[236:239], a[252:255], v[188:191]
  v_add_f32 v240, v240, v241
  v_add_f32 v242, v242, v243
  v_cndmask_b32 v44, v32, v33, s[44:45]
  v_mov_b32 v45, 0
  v_add_f32 v46, v240, v242
  v_mov_b32 v47, 0
  s_nop 3
  v_cvt_pk_bf16_f32 v104, v160, v164
  v_cvt_pk_bf16_f32 v105, v168, v172
  v_cvt_pk_bf16_f32 v106, v176, v180
  v_cvt_pk_bf16_f32 v107, v184, v188
  buffer_store_dwordx4 v[104:107], v124, s[8:11], s35 offen offset:0 sc1
  v_cvt_pk_bf16_f32 v108, v161, v165
  v_cvt_pk_bf16_f32 v109, v169, v173
  v_cvt_pk_bf16_f32 v110, v177, v181
  v_cvt_pk_bf16_f32 v111, v185, v189
  buffer_store_dwordx4 v[108:111], v124, s[8:11], s35 offen offset:256 sc1
  v_cvt_pk_bf16_f32 v112, v162, v166
  v_cvt_pk_bf16_f32 v113, v170, v174
  v_cvt_pk_bf16_f32 v114, v178, v182
  v_cvt_pk_bf16_f32 v115, v186, v190
  buffer_store_dwordx4 v[112:115], v124, s[8:11], s35 offen offset:512 sc1
  v_cvt_pk_bf16_f32 v116, v163, v167
  v_cvt_pk_bf16_f32 v117, v171, v175
  v_cvt_pk_bf16_f32 v118, v179, v183
  v_cvt_pk_bf16_f32 v119, v187, v191
  buffer_store_dwordx4 v[116:119], v124, s[8:11], s35 offen offset:768 sc1
  s_mov_b32 exec_lo, -1
  s_mov_b32 exec_hi, 0
  buffer_store_dwordx4 v[44:47], v125, s[8:11], s36 offen sc1
  s_mov_b64 exec, 0xff
  s_waitcnt vmcnt(0)
  buffer_store_dwordx2 v[252:253], v126, s[8:11], s37 offen sc1
  s_mov_b64 exec, -1
L_adone:
L_end:
  s_endpgm
.section .rodata,"a"
.p2align 6
.amdhsa_kernel parallel_sum__compressed_kv_cla__glu_gated_swiglu__decode_kernel
  .amdhsa_next_free_vgpr 512
  .amdhsa_next_free_sgpr 102
  .amdhsa_accum_offset 256
  .amdhsa_group_segment_fixed_size 0
  .amdhsa_kernarg_size 104
  .amdhsa_user_sgpr_count 2
  .amdhsa_user_sgpr_kernarg_segment_ptr 1
  .amdhsa_system_sgpr_workgroup_id_x 1
.end_amdhsa_kernel
```
